```python
import torch

def _softmax(x, axis=-1):
    return torch.softmax(x, dim=axis)
def _gelu(x):
    return torch.nn.functional.gelu(x, approximate="tanh")
def _silu(x):
    return torch.nn.functional.silu(x)
def _sigmoid(x):
    return torch.sigmoid(x)
def _layernorm(x, axis=-1, eps=1e-5):
    m = x.mean(dim=axis, keepdim=True)
    v = x.var(dim=axis, keepdim=True, unbiased=False)
    return (x - m) / torch.sqrt(v + eps)
def _scatter_add(tgt, idx, src, axis=0):
    return tgt.clone().index_add_(axis, idx, src)
def _segment_sum(src, seg, n):
    out = torch.zeros((n,) + src.shape[1:], dtype=src.dtype)
    return out.index_add_(0, seg, src)
def _pad(x, pw):
    flat = tuple(v for pair in reversed(pw) for v in pair)
    return torch.nn.functional.pad(x, flat)

kernel_name = 'parallel_sum__ssm_conv_s4__dense_activation_mish__prompt'

def setup_inputs():

    _w = (lambda a: (lambda t: t.to(torch.bfloat16) if t.is_floating_point() else t)(torch.as_tensor(a)))
    def _A_setup():
        B, L, D, N = 1, 2048, 512, 128
        A_re = -(lambda _x: torch.exp(torch.as_tensor(_x)))((lambda *s: torch.randn(*s, dtype=torch.bfloat16) * 6.4)(D, N))
        A_im = torch.pi * (lambda *s: torch.randn(*s, dtype=torch.bfloat16) * 0.05)(D, N)
        B_re = (lambda *s: torch.randn(*s, dtype=torch.bfloat16) * 0.1)(D, N)
        B_im = (lambda *s: torch.randn(*s, dtype=torch.bfloat16) * 0.1)(D, N)
        C_re = (lambda *s: torch.randn(*s, dtype=torch.bfloat16) * 0.1)(D, N)
        C_im = (lambda *s: torch.randn(*s, dtype=torch.bfloat16) * 0.1)(D, N)
        log_dt = (lambda *s: torch.randn(*s, dtype=torch.bfloat16) * 0.05)(D) * 0.5 - 4.0
        Dskip = (lambda *s: torch.randn(*s, dtype=torch.bfloat16) * 0.05)(D)
        return {
            "u": _w((lambda *s: torch.randn(*s, dtype=torch.bfloat16) * 0.05)(B, L, D)),
            "A_re": _w(A_re),
            "A_im": _w(A_im),
            "B_re": _w(B_re),
            "B_im": _w(B_im),
            "C_re": _w(C_re),
            "C_im": _w(C_im),
            "log_dt": _w(log_dt),
            "Dskip": _w(Dskip),
        }
    _A_in = _A_setup()

    def _B_setup():
        B, S, D, F = 1, 2048, 512, 1792
        return {
            "x": _w((lambda *s: torch.randn(*s, dtype=torch.bfloat16) * 0.05)(B, S, D)),
            "w1": _w((lambda *s: torch.randn(*s, dtype=torch.bfloat16) * 0.8)(D, F) * (D ** -0.5)),
            "b1": _w((lambda *s: torch.randn(*s, dtype=torch.bfloat16) * 0.2)(F)),
            "w2": _w((lambda *s: torch.randn(*s, dtype=torch.bfloat16) * 0.2)(F, D) * (F ** -0.5)),
        }
    _B_in = _B_setup()

    return {
        "A_u": _A_in["u"],
        "A_A_re": _A_in["A_re"],
        "A_A_im": _A_in["A_im"],
        "A_B_re": _A_in["B_re"],
        "A_B_im": _A_in["B_im"],
        "A_C_re": _A_in["C_re"],
        "A_C_im": _A_in["C_im"],
        "A_log_dt": _A_in["log_dt"],
        "A_Dskip": _A_in["Dskip"],
        "B_x": _B_in["x"],
        "B_w1": _B_in["w1"],
        "B_b1": _B_in["b1"],
        "B_w2": _B_in["w2"],
    }

def reference(A_u, A_A_re, A_A_im, A_B_re, A_B_im, A_C_re, A_C_im, A_log_dt, A_Dskip, B_x, B_w1, B_b1, B_w2):
    def _A_ref(u, A_re, A_im, B_re, B_im, C_re, C_im, log_dt, Dskip):
        Bsz, L, D = u.shape
        dt = torch.exp(log_dt)[:, None]
        A = A_re + 1j * A_im
        Bc = B_re + 1j * B_im
        Cc = C_re + 1j * C_im
        logdA = dt * A
        dB = dt * Bc
        l = (lambda x, dt: x.to(dt))(torch.arange(L), A_re.dtype)
        P = torch.exp(logdA[:, :, None] * l[None, None, :])
        K = torch.einsum("dn,dnl,dn->dl", Cc, P, dB).real
        L2 = 2 * L
        Kp = _pad(K, ((0, 0), (0, L)))
        up = (lambda x, *d: x.permute(*d))(u, 0, 2, 1)
        up = _pad(up, ((0, 0), (0, 0), (0, L)))
        Kf = (lambda x, axes=(-2,-1): torch.fft.rfft2(x.float(), dim=axes))(Kp[:, None, :], axes=(-2, -1))
        Uf = (lambda x, axes=(-2,-1): torch.fft.rfft2(x.float(), dim=axes))(up[:, :, None, :], axes=(-2, -1))
        Yf = Uf * Kf[None, :, :, :]
        y = (lambda x, s, axes=(-2,-1): torch.fft.irfft2(x, s=s, dim=axes).to(torch.bfloat16))(Yf, (1, L2), axes=(-2, -1))[:, :, 0, :L]
        y = (lambda x, *d: x.permute(*d))(y, 0, 2, 1) + u * Dskip[None, None, :]
        return y

    def _B_ref(x, w1, b1, w2):
        h = torch.einsum("bsd,df->bsf", x, w1) + b1
        sp = torch.log1p(torch.exp(-torch.abs(h))) + torch.where(h > 0, h, torch.zeros_like(h))
        act = h * torch.tanh(sp)
        return torch.einsum("bsf,fd->bsd", act, w2)

    x = A_u
    xn = _layernorm(x, axis=-1)
    return x + _A_ref(xn, A_A_re, A_A_im, A_B_re, A_B_im, A_C_re, A_C_im, A_log_dt, A_Dskip) + _B_ref(xn, B_w1, B_b1, B_w2)
```

```asm
; @launch grid=(512,1,1) block=(512,1,1) lds=81920
.amdgcn_target "amdgcn-amd-amdhsa--gfx950"
.text
.globl parallel_sum__ssm_conv_s4__dense_activation_mish__prompt_kernel
.p2align 8
.type parallel_sum__ssm_conv_s4__dense_activation_mish__prompt_kernel,@function
parallel_sum__ssm_conv_s4__dense_activation_mish__prompt_kernel:
    s_cmp_ge_u32 s2, 512
    s_cbranch_scc1 M_END
    s_load_dwordx4 s[20:23], s[0:1], 112
    v_and_b32 v1, 63, v0
    v_lshrrev_b32 v2, 6, v0
    s_nop 0
    v_readfirstlane_b32 s3, v2
    s_mov_b32 s95, s2
    s_mov_b32 s94, s3
    s_cmp_ge_u32 s2, 256
    s_cbranch_scc1 M_G
    s_setprio 3
    s_load_dwordx4 s[4:7], s[0:1], 56
    s_min_u32 s36, s3, 5
    s_lshl_b32 s36, s36, 3
    s_add_u32 s36, s36, 8
    s_load_dwordx2 s[8:9], s[0:1], s36
    s_lshl_b32 s28, s2, 2
    s_lshl_b32 s36, s2, 9
    v_and_b32 v5, 31, v1
    v_lshlrev_b32 v5, 4, v5
    v_add_u32 v6, s36, v5
    s_waitcnt lgkmcnt(0)
    s_load_dword s52, s[4:5], s28
    s_load_dword s53, s[6:7], s28
    global_load_dwordx4 v[112:115], v6, s[8:9]
    s_cmp_lg_u32 s2, 0
    s_cbranch_scc1 M_NOZ
    v_lshrrev_b32 v4, 6, v0
    v_lshlrev_b32 v4, 12, v4
    v_lshlrev_b32 v5, 2, v1
    v_add_u32 v4, v4, v5
    v_add_u32 v4, 6553600, v4
    v_add_u32 v5, 0x8000, v4
    v_add_u32 v6, 0x10000, v4
    v_add_u32 v7, 0x18000, v4
    v_mov_b32 v8, 0
    global_store_dword v4, v8, s[22:23] sc1
    global_store_dword v5, v8, s[22:23] sc1
    global_store_dword v6, v8, s[22:23] sc1
    global_store_dword v7, v8, s[22:23] sc1
    v_mov_b32 v9, 0
    v_mov_b32 v10, 0
    v_mov_b32 v11, 0
    v_lshlrev_b32 v4, 4, v0
    v_add_u32 v4, 6815744, v4
    global_store_dwordx4 v4, v[8:11], s[22:23] sc1
    v_add_u32 v4, 8192, v4
    global_store_dwordx4 v4, v[8:11], s[22:23] sc1
    v_add_u32 v4, 8192, v4
    global_store_dwordx4 v4, v[8:11], s[22:23] sc1
    v_add_u32 v4, 8192, v4
    global_store_dwordx4 v4, v[8:11], s[22:23] sc1
    v_add_u32 v4, 8192, v4
    global_store_dwordx4 v4, v[8:11], s[22:23] sc1
    v_add_u32 v4, 8192, v4
    global_store_dwordx4 v4, v[8:11], s[22:23] sc1
    v_add_u32 v4, 8192, v4
    global_store_dwordx4 v4, v[8:11], s[22:23] sc1
    v_add_u32 v4, 8192, v4
    global_store_dwordx4 v4, v[8:11], s[22:23] sc1
    s_waitcnt vmcnt(0)
    s_barrier
    s_cmp_lg_u32 s3, 0
    s_cbranch_scc1 M_NOZ
    v_mov_b32 v4, 0
    v_mov_b32 v5, 0x01010101
    v_cmp_eq_u32 vcc, 0, v1
    s_and_saveexec_b64 s[50:51], vcc
    global_store_dword v4, v5, s[20:21] sc1
    s_mov_b64 exec, s[50:51]
M_NOZ:
    s_mov_b32 s55, 0
    s_cmp_ge_u32 s2, 128
    s_cbranch_scc1 M_NOTLN
    s_load_dwordx2 s[4:5], s[0:1], 0
    s_lshl_b32 s6, s2, 4
    s_lshl_b32 s7, s3, 1
    s_add_u32 s6, s6, s7
    s_lshl_b32 s7, s6, 10
    v_lshlrev_b32 v3, 4, v1
    s_waitcnt lgkmcnt(0)
    s_mov_b32 s8, s4
    s_mov_b32 s9, s5
    s_mov_b32 s10, 2097152
    s_mov_b32 s11, 0x00020000
    s_add_u32 s16, s22, 2097152
    s_addc_u32 s17, s23, 0
    s_mov_b32 s18, 2097152
    s_mov_b32 s19, 0x00020000
    buffer_load_dwordx4 v[16:19], v3, s[8:11], s7 offen offset:0
    buffer_load_dwordx4 v[20:23], v3, s[8:11], s7 offen offset:1024
    s_waitcnt vmcnt(0)
    v_lshlrev_b32 v32, 16, v16
    v_and_b32 v33, 0xffff0000, v16
    v_lshlrev_b32 v34, 16, v17
    v_and_b32 v35, 0xffff0000, v17
    v_lshlrev_b32 v36, 16, v18
    v_and_b32 v37, 0xffff0000, v18
    v_lshlrev_b32 v38, 16, v19
    v_and_b32 v39, 0xffff0000, v19
    v_lshlrev_b32 v40, 16, v20
    v_and_b32 v41, 0xffff0000, v20
    v_lshlrev_b32 v42, 16, v21
    v_and_b32 v43, 0xffff0000, v21
    v_lshlrev_b32 v44, 16, v22
    v_and_b32 v45, 0xffff0000, v22
    v_lshlrev_b32 v46, 16, v23
    v_and_b32 v47, 0xffff0000, v23
    v_add_f32 v4, v32, v33
    v_add_f32 v8, v34, v35
    v_add_f32 v12, v36, v37
    v_add_f32 v64, v38, v39
    v_add_f32 v5, v40, v41
    v_add_f32 v9, v42, v43
    v_add_f32 v13, v44, v45
    v_add_f32 v65, v46, v47
    v_add_f32 v4, v4, v8
    v_add_f32 v12, v12, v64
    v_add_f32 v5, v5, v9
    v_add_f32 v13, v13, v65
    v_add_f32 v4, v4, v12
    v_add_f32 v5, v5, v13
    s_nop 1
    v_add_f32_dpp v4, v4, v4 quad_perm:[1,0,3,2]
    v_add_f32_dpp v5, v5, v5 quad_perm:[1,0,3,2]
    s_nop 0
    v_add_f32_dpp v4, v4, v4 quad_perm:[2,3,0,1]
    v_add_f32_dpp v5, v5, v5 quad_perm:[2,3,0,1]
    s_nop 0
    v_add_f32_dpp v4, v4, v4 row_half_mirror
    v_add_f32_dpp v5, v5, v5 row_half_mirror
    s_nop 0
    v_add_f32_dpp v4, v4, v4 row_mirror
    v_add_f32_dpp v5, v5, v5 row_mirror
    s_nop 0
    v_add_f32_dpp v4, v4, v4 row_bcast:15 row_mask:0xa
    v_add_f32_dpp v5, v5, v5 row_bcast:15 row_mask:0xa
    s_nop 0
    v_add_f32_dpp v4, v4, v4 row_bcast:31 row_mask:0xc
    v_add_f32_dpp v5, v5, v5 row_bcast:31 row_mask:0xc
    s_nop 0
    v_readlane_b32 s32, v4, 63
    v_readlane_b32 s33, v5, 63
    s_nop 1
    v_mov_b32 v4, s32
    v_mov_b32 v5, s33
    v_mul_f32 v4, 0x3b000000, v4
    v_mul_f32 v5, 0x3b000000, v5
    v_sub_f32 v64, v32, v4
    v_sub_f32 v65, v33, v4
    v_sub_f32 v66, v34, v4
    v_sub_f32 v67, v35, v4
    v_sub_f32 v68, v36, v4
    v_sub_f32 v69, v37, v4
    v_sub_f32 v70, v38, v4
    v_sub_f32 v71, v39, v4
    v_mul_f32 v8, v64, v64
    v_mul_f32 v12, v65, v65
    v_fma_f32 v8, v66, v66, v8
    v_fma_f32 v12, v67, v67, v12
    v_fma_f32 v8, v68, v68, v8
    v_fma_f32 v12, v69, v69, v12
    v_fma_f32 v8, v70, v70, v8
    v_fma_f32 v12, v71, v71, v12
    v_add_f32 v8, v8, v12
    v_sub_f32 v64, v40, v5
    v_sub_f32 v65, v41, v5
    v_sub_f32 v66, v42, v5
    v_sub_f32 v67, v43, v5
    v_sub_f32 v68, v44, v5
    v_sub_f32 v69, v45, v5
    v_sub_f32 v70, v46, v5
    v_sub_f32 v71, v47, v5
    v_mul_f32 v9, v64, v64
    v_mul_f32 v13, v65, v65
    v_fma_f32 v9, v66, v66, v9
    v_fma_f32 v13, v67, v67, v13
    v_fma_f32 v9, v68, v68, v9
    v_fma_f32 v13, v69, v69, v13
    v_fma_f32 v9, v70, v70, v9
    v_fma_f32 v13, v71, v71, v13
    v_add_f32 v9, v9, v13
    s_nop 1
    v_add_f32_dpp v8, v8, v8 quad_perm:[1,0,3,2]
    v_add_f32_dpp v9, v9, v9 quad_perm:[1,0,3,2]
    s_nop 0
    v_add_f32_dpp v8, v8, v8 quad_perm:[2,3,0,1]
    v_add_f32_dpp v9, v9, v9 quad_perm:[2,3,0,1]
    s_nop 0
    v_add_f32_dpp v8, v8, v8 row_half_mirror
    v_add_f32_dpp v9, v9, v9 row_half_mirror
    s_nop 0
    v_add_f32_dpp v8, v8, v8 row_mirror
    v_add_f32_dpp v9, v9, v9 row_mirror
    s_nop 0
    v_add_f32_dpp v8, v8, v8 row_bcast:15 row_mask:0xa
    v_add_f32_dpp v9, v9, v9 row_bcast:15 row_mask:0xa
    s_nop 0
    v_add_f32_dpp v8, v8, v8 row_bcast:31 row_mask:0xc
    v_add_f32_dpp v9, v9, v9 row_bcast:31 row_mask:0xc
    s_nop 0
    v_readlane_b32 s32, v8, 63
    v_readlane_b32 s33, v9, 63
    s_nop 1
    v_mov_b32 v8, s32
    v_mov_b32 v9, s33
    v_mul_f32 v8, 0x3b000000, v8
    v_mul_f32 v9, 0x3b000000, v9
    v_cvt_pk_bf16_f32 v12, v4, v8
    v_cvt_pk_bf16_f32 v13, v5, v9
    v_lshlrev_b32 v4, 16, v12
    v_and_b32 v8, 0xffff0000, v12
    v_lshlrev_b32 v5, 16, v13
    v_and_b32 v9, 0xffff0000, v13
    v_add_f32 v8, 0x3727c5ac, v8
    v_add_f32 v9, 0x3727c5ac, v9
    v_cvt_pk_bf16_f32 v8, v8, v8
    v_cvt_pk_bf16_f32 v9, v9, v9
    v_lshlrev_b32 v8, 16, v8
    v_lshlrev_b32 v9, 16, v9
    v_sqrt_f32 v8, v8
    v_sqrt_f32 v9, v9
    s_nop 0
    v_cvt_pk_bf16_f32 v8, v8, v8
    v_cvt_pk_bf16_f32 v9, v9, v9
    v_lshlrev_b32 v8, 16, v8
    v_lshlrev_b32 v9, 16, v9
    v_rcp_f32 v12, v8
    v_rcp_f32 v13, v9
    s_nop 0
    v_fma_f32 v64, -v8, v12, 1.0
    v_fma_f32 v65, -v9, v13, 1.0
    v_fma_f32 v17, v64, v12, v12
    v_fma_f32 v19, v65, v13, v13
    v_mul_f32 v16, v4, v17
    v_mul_f32 v18, v5, v19
    s_lshl_b32 s42, s6, 3
    v_mov_b32 v24, s42
    s_add_u32 s44, s22, 0
    s_addc_u32 s45, s23, 0
    v_cmp_eq_u32 vcc, 0, v1
    s_and_saveexec_b64 s[46:47], vcc
    global_store_dwordx4 v24, v[16:19], s[44:45] sc1
    s_mov_b64 exec, s[46:47]
    s_mul_i32 s36, s3, 2112
    s_add_u32 s36, s36, 55360
    v_add_u32 v2, s36, v3
    v_sub_f32 v32, v32, v4
    v_sub_f32 v33, v33, v4
    v_sub_f32 v34, v34, v4
    v_sub_f32 v35, v35, v4
    v_sub_f32 v36, v36, v4
    v_sub_f32 v37, v37, v4
    v_sub_f32 v38, v38, v4
    v_sub_f32 v39, v39, v4
    v_cvt_pk_bf16_f32 v64, v32, v33
    v_cvt_pk_bf16_f32 v65, v34, v35
    v_cvt_pk_bf16_f32 v66, v36, v37
    v_cvt_pk_bf16_f32 v67, v38, v39
    v_lshlrev_b32 v32, 16, v64
    v_and_b32 v33, 0xffff0000, v64
    v_lshlrev_b32 v34, 16, v65
    v_and_b32 v35, 0xffff0000, v65
    v_lshlrev_b32 v36, 16, v66
    v_and_b32 v37, 0xffff0000, v66
    v_lshlrev_b32 v38, 16, v67
    v_and_b32 v39, 0xffff0000, v67
    v_mul_f32 v64, v32, v12
    v_mul_f32 v65, v33, v12
    v_mul_f32 v66, v34, v12
    v_mul_f32 v67, v35, v12
    v_mul_f32 v68, v36, v12
    v_mul_f32 v69, v37, v12
    v_mul_f32 v70, v38, v12
    v_mul_f32 v71, v39, v12
    v_fma_f32 v32, -v64, v8, v32
    v_fma_f32 v33, -v65, v8, v33
    v_fma_f32 v34, -v66, v8, v34
    v_fma_f32 v35, -v67, v8, v35
    v_fma_f32 v36, -v68, v8, v36
    v_fma_f32 v37, -v69, v8, v37
    v_fma_f32 v38, -v70, v8, v38
    v_fma_f32 v39, -v71, v8, v39
    v_fma_f32 v64, v32, v12, v64
    v_fma_f32 v65, v33, v12, v65
    v_fma_f32 v66, v34, v12, v66
    v_fma_f32 v67, v35, v12, v67
    v_fma_f32 v68, v36, v12, v68
    v_fma_f32 v69, v37, v12, v69
    v_fma_f32 v70, v38, v12, v70
    v_fma_f32 v71, v39, v12, v71
    v_cvt_pk_bf16_f32 v72, v64, v65
    v_cvt_pk_bf16_f32 v73, v66, v67
    v_cvt_pk_bf16_f32 v74, v68, v69
    v_cvt_pk_bf16_f32 v75, v70, v71
    v_lshlrev_b32 v64, 16, v72
    v_and_b32 v65, 0xffff0000, v72
    v_lshlrev_b32 v66, 16, v73
    v_and_b32 v67, 0xffff0000, v73
    v_lshlrev_b32 v68, 16, v74
    v_and_b32 v69, 0xffff0000, v74
    v_lshlrev_b32 v70, 16, v75
    v_and_b32 v71, 0xffff0000, v75
    v_cvt_pk_f16_f32 v76, v64, v65
    v_cvt_pk_f16_f32 v77, v66, v67
    v_cvt_pk_f16_f32 v78, v68, v69
    v_cvt_pk_f16_f32 v79, v70, v71
    ds_write_b128 v2, v[76:79] offset:0
    v_sub_f32 v40, v40, v5
    v_sub_f32 v41, v41, v5
    v_sub_f32 v42, v42, v5
    v_sub_f32 v43, v43, v5
    v_sub_f32 v44, v44, v5
    v_sub_f32 v45, v45, v5
    v_sub_f32 v46, v46, v5
    v_sub_f32 v47, v47, v5
    v_cvt_pk_bf16_f32 v64, v40, v41
    v_cvt_pk_bf16_f32 v65, v42, v43
    v_cvt_pk_bf16_f32 v66, v44, v45
    v_cvt_pk_bf16_f32 v67, v46, v47
    v_lshlrev_b32 v40, 16, v64
    v_and_b32 v41, 0xffff0000, v64
    v_lshlrev_b32 v42, 16, v65
    v_and_b32 v43, 0xffff0000, v65
    v_lshlrev_b32 v44, 16, v66
    v_and_b32 v45, 0xffff0000, v66
    v_lshlrev_b32 v46, 16, v67
    v_and_b32 v47, 0xffff0000, v67
    v_mul_f32 v64, v40, v13
    v_mul_f32 v65, v41, v13
    v_mul_f32 v66, v42, v13
    v_mul_f32 v67, v43, v13
    v_mul_f32 v68, v44, v13
    v_mul_f32 v69, v45, v13
    v_mul_f32 v70, v46, v13
    v_mul_f32 v71, v47, v13
    v_fma_f32 v40, -v64, v9, v40
    v_fma_f32 v41, -v65, v9, v41
    v_fma_f32 v42, -v66, v9, v42
    v_fma_f32 v43, -v67, v9, v43
    v_fma_f32 v44, -v68, v9, v44
    v_fma_f32 v45, -v69, v9, v45
    v_fma_f32 v46, -v70, v9, v46
    v_fma_f32 v47, -v71, v9, v47
    v_fma_f32 v64, v40, v13, v64
    v_fma_f32 v65, v41, v13, v65
    v_fma_f32 v66, v42, v13, v66
    v_fma_f32 v67, v43, v13, v67
    v_fma_f32 v68, v44, v13, v68
    v_fma_f32 v69, v45, v13, v69
    v_fma_f32 v70, v46, v13, v70
    v_fma_f32 v71, v47, v13, v71
    v_cvt_pk_bf16_f32 v72, v64, v65
    v_cvt_pk_bf16_f32 v73, v66, v67
    v_cvt_pk_bf16_f32 v74, v68, v69
    v_cvt_pk_bf16_f32 v75, v70, v71
    v_lshlrev_b32 v64, 16, v72
    v_and_b32 v65, 0xffff0000, v72
    v_lshlrev_b32 v66, 16, v73
    v_and_b32 v67, 0xffff0000, v73
    v_lshlrev_b32 v68, 16, v74
    v_and_b32 v69, 0xffff0000, v74
    v_lshlrev_b32 v70, 16, v75
    v_and_b32 v71, 0xffff0000, v75
    v_cvt_pk_f16_f32 v80, v64, v65
    v_cvt_pk_f16_f32 v81, v66, v67
    v_cvt_pk_f16_f32 v82, v68, v69
    v_cvt_pk_f16_f32 v83, v70, v71
    ds_write_b128 v2, v[80:83] offset:1056
    s_waitcnt lgkmcnt(0)
    s_barrier
    v_and_b32 v4, 15, v1
    v_lshrrev_b32 v5, 4, v1
    v_and_b32 v6, 1, v5
    v_lshrrev_b32 v5, 1, v5
    v_lshlrev_b32 v7, 3, v6
    v_lshrrev_b32 v8, 2, v4
    v_add_u32 v7, v7, v8
    v_mul_u32_u24 v7, 1056, v7
    v_and_b32 v8, 3, v4
    v_lshlrev_b32 v8, 3, v8
    v_add_u32 v7, v7, v8
    v_lshlrev_b32 v8, 5, v5
    v_add_u32 v7, v7, v8
    s_lshl_b32 s36, s3, 7
    s_add_u32 s36, s36, 55360
    v_add_u32 v7, s36, v7
    ds_read_b64_tr_b16 v[16:17], v7
    ds_read_b64_tr_b16 v[18:19], v7 offset:4224
    ds_read_b64_tr_b16 v[20:21], v7 offset:64
    ds_read_b64_tr_b16 v[22:23], v7 offset:4288
    v_lshlrev_b32 v8, 4, v5
    v_add_u32 v8, v8, v4
    v_lshlrev_b32 v8, 5, v8
    v_lshlrev_b32 v9, 4, v6
    v_add_u32 v8, v8, v9
    s_lshl_b32 s36, s2, 14
    s_lshl_b32 s37, s3, 11
    s_add_u32 s36, s36, s37
    s_waitcnt lgkmcnt(0)
    buffer_store_dwordx4 v[16:19], v8, s[16:19], s36 offen sc1
    buffer_store_dwordx4 v[20:23], v8, s[16:19], s36 offen offset:1024 sc1
    s_and_b32 s55, s2, 63
    s_lshl_b32 s55, s55, 2
    s_lshr_b32 s37, s2, 6
    s_mul_i32 s37, s37, 118784
    s_add_u32 s55, s55, s37
    s_add_u32 s55, s55, 6553600
    v_mov_b32 v4, 0
    global_load_dword v117, v4, s[20:21] sc1
    s_branch M_CONV
M_NOTLN:
    s_cmp_ge_u32 s2, 240
    s_cbranch_scc1 M_NOROLE
    s_load_dwordx2 s[6:7], s[0:1], 96
    v_and_b32 v4, 15, v1
    v_lshrrev_b32 v5, 4, v1
    s_sub_u32 s38, s2, 128
    s_lshr_b32 s24, s38, 2
    s_and_b32 s25, s38, 3
    v_lshlrev_b32 v8, 4, v1
    s_lshl_b32 s28, s25, 3
    s_add_u32 s28, s28, s3
    s_mul_i32 s28, s28, 56
    s_lshl_b32 s29, s24, 1
    s_add_u32 s28, s28, s29
    s_lshl_b32 s28, s28, 10
    v_lshrrev_b32 v3, 4, v0
    v_and_b32 v6, 15, v0
    v_lshlrev_b32 v7, 10, v3
    v_lshlrev_b32 v6, 4, v6
    v_add_u32 v7, v7, v6
    s_lshl_b32 s30, s24, 16
    s_lshl_b32 s31, s25, 8
    s_add_u32 s30, s30, s31
    s_add_u32 s31, s30, 32768
    s_waitcnt lgkmcnt(0)
    s_mov_b32 s8, s6
    s_mov_b32 s9, s7
    s_mov_b32 s10, 1835008
    s_mov_b32 s11, 0x00020000
    s_add_u32 s12, s22, 8388608
    s_addc_u32 s13, s23, 0
    s_mov_b32 s14, 1835008
    s_mov_b32 s15, 0x00020000
    buffer_load_dwordx4 v[12:15], v7, s[8:11], s30 offen
    buffer_load_dwordx4 v[16:19], v7, s[8:11], s31 offen
    v_mul_u32_u24 v10, 288, v3
    v_add_u32 v10, v10, v6
    v_add_u32 v10, 55360, v10
    v_lshlrev_b32 v6, 3, v5
    v_lshrrev_b32 v7, 2, v4
    v_add_u32 v6, v6, v7
    v_mul_u32_u24 v6, 288, v6
    v_and_b32 v7, 3, v4
    v_lshlrev_b32 v7, 3, v7
    v_add_u32 v6, v6, v7
    s_lshl_b32 s36, s3, 5
    s_add_u32 s36, s36, 55360
    v_add_u32 v6, s36, v6
    s_waitcnt vmcnt(0)
    ds_write_b128 v10, v[12:15]
    ds_write_b128 v10, v[16:19] offset:9216
    s_waitcnt lgkmcnt(0)
    s_barrier
    ds_read_b64_tr_b16 v[20:21], v6
    ds_read_b64_tr_b16 v[22:23], v6 offset:1152
    ds_read_b64_tr_b16 v[24:25], v6 offset:9216
    ds_read_b64_tr_b16 v[26:27], v6 offset:10368
    s_waitcnt lgkmcnt(0)
    buffer_store_dwordx4 v[20:23], v8, s[12:15], s28 offen sc1
    buffer_store_dwordx4 v[24:27], v8, s[12:15], s28 offen offset:1024 sc1
    s_add_u32 s55, s25, 1
    s_lshl_b32 s55, s55, 12
    s_lshl_b32 s37, s24, 2
    s_add_u32 s55, s55, s37
    s_add_u32 s55, s55, 6553600
    v_mov_b32 v4, 0
    global_load_dword v117, v4, s[20:21] sc1
    s_branch M_CONV
M_NOROLE:
    s_cmp_ge_u32 s2, 254
    s_cbranch_scc1 M_NOROLE2
    s_load_dwordx4 s[4:7], s[0:1], 80
    s_sub_u32 s38, s2, 240
    v_lshrrev_b32 v7, 4, v0
    v_and_b32 v8, 15, v0
    v_mul_u32_u24 v9, 57344, v7
    v_lshlrev_b32 v8, 4, v8
    v_add_u32 v9, v9, v8
    s_lshl_b32 s40, s38, 8
    v_and_b32 v10, 127, v0
    v_lshlrev_b32 v10, 1, v10
    v_add_u32 v10, s40, v10
    s_waitcnt lgkmcnt(0)
    s_mov_b32 s8, s4
    s_mov_b32 s9, s5
    s_mov_b32 s10, 1835008
    s_mov_b32 s11, 0x00020000
    global_load_ushort v11, v10, s[6:7]
    s_add_u32 s41, s40, 0
    buffer_load_dwordx4 v[16:19], v9, s[8:11], s41 offen
    s_add_u32 s41, s40, 3584
    buffer_load_dwordx4 v[20:23], v9, s[8:11], s41 offen
    s_add_u32 s41, s40, 7168
    buffer_load_dwordx4 v[24:27], v9, s[8:11], s41 offen
    s_add_u32 s41, s40, 10752
    buffer_load_dwordx4 v[28:31], v9, s[8:11], s41 offen
    s_add_u32 s41, s40, 14336
    buffer_load_dwordx4 v[32:35], v9, s[8:11], s41 offen
    s_add_u32 s41, s40, 17920
    buffer_load_dwordx4 v[36:39], v9, s[8:11], s41 offen
    s_add_u32 s41, s40, 21504
    buffer_load_dwordx4 v[40:43], v9, s[8:11], s41 offen
    s_add_u32 s41, s40, 25088
    buffer_load_dwordx4 v[44:47], v9, s[8:11], s41 offen
    s_add_u32 s41, s40, 28672
    buffer_load_dwordx4 v[48:51], v9, s[8:11], s41 offen
    s_add_u32 s41, s40, 32256
    buffer_load_dwordx4 v[52:55], v9, s[8:11], s41 offen
    s_add_u32 s41, s40, 35840
    buffer_load_dwordx4 v[56:59], v9, s[8:11], s41 offen
    s_add_u32 s41, s40, 39424
    buffer_load_dwordx4 v[60:63], v9, s[8:11], s41 offen
    s_add_u32 s41, s40, 43008
    buffer_load_dwordx4 v[64:67], v9, s[8:11], s41 offen
    s_add_u32 s41, s40, 46592
    buffer_load_dwordx4 v[68:71], v9, s[8:11], s41 offen
    s_add_u32 s41, s40, 50176
    buffer_load_dwordx4 v[72:75], v9, s[8:11], s41 offen
    s_add_u32 s41, s40, 53760
    buffer_load_dwordx4 v[76:79], v9, s[8:11], s41 offen
    s_waitcnt vmcnt(0)
    v_lshlrev_b32 v80, 16, v16
    v_and_b32 v81, 0xffff0000, v16
    v_lshlrev_b32 v82, 16, v17
    v_and_b32 v83, 0xffff0000, v17
    v_lshlrev_b32 v84, 16, v18
    v_and_b32 v85, 0xffff0000, v18
    v_lshlrev_b32 v86, 16, v19
    v_and_b32 v87, 0xffff0000, v19
    v_lshlrev_b32 v12, 16, v20
    v_and_b32 v13, 0xffff0000, v20
    v_add_f32 v80, v80, v12
    v_add_f32 v81, v81, v13
    v_lshlrev_b32 v12, 16, v21
    v_and_b32 v13, 0xffff0000, v21
    v_add_f32 v82, v82, v12
    v_add_f32 v83, v83, v13
    v_lshlrev_b32 v12, 16, v22
    v_and_b32 v13, 0xffff0000, v22
    v_add_f32 v84, v84, v12
    v_add_f32 v85, v85, v13
    v_lshlrev_b32 v12, 16, v23
    v_and_b32 v13, 0xffff0000, v23
    v_add_f32 v86, v86, v12
    v_add_f32 v87, v87, v13
    v_lshlrev_b32 v12, 16, v24
    v_and_b32 v13, 0xffff0000, v24
    v_add_f32 v80, v80, v12
    v_add_f32 v81, v81, v13
    v_lshlrev_b32 v12, 16, v25
    v_and_b32 v13, 0xffff0000, v25
    v_add_f32 v82, v82, v12
    v_add_f32 v83, v83, v13
    v_lshlrev_b32 v12, 16, v26
    v_and_b32 v13, 0xffff0000, v26
    v_add_f32 v84, v84, v12
    v_add_f32 v85, v85, v13
    v_lshlrev_b32 v12, 16, v27
    v_and_b32 v13, 0xffff0000, v27
    v_add_f32 v86, v86, v12
    v_add_f32 v87, v87, v13
    v_lshlrev_b32 v12, 16, v28
    v_and_b32 v13, 0xffff0000, v28
    v_add_f32 v80, v80, v12
    v_add_f32 v81, v81, v13
    v_lshlrev_b32 v12, 16, v29
    v_and_b32 v13, 0xffff0000, v29
    v_add_f32 v82, v82, v12
    v_add_f32 v83, v83, v13
    v_lshlrev_b32 v12, 16, v30
    v_and_b32 v13, 0xffff0000, v30
    v_add_f32 v84, v84, v12
    v_add_f32 v85, v85, v13
    v_lshlrev_b32 v12, 16, v31
    v_and_b32 v13, 0xffff0000, v31
    v_add_f32 v86, v86, v12
    v_add_f32 v87, v87, v13
    v_lshlrev_b32 v12, 16, v32
    v_and_b32 v13, 0xffff0000, v32
    v_add_f32 v80, v80, v12
    v_add_f32 v81, v81, v13
    v_lshlrev_b32 v12, 16, v33
    v_and_b32 v13, 0xffff0000, v33
    v_add_f32 v82, v82, v12
    v_add_f32 v83, v83, v13
    v_lshlrev_b32 v12, 16, v34
    v_and_b32 v13, 0xffff0000, v34
    v_add_f32 v84, v84, v12
    v_add_f32 v85, v85, v13
    v_lshlrev_b32 v12, 16, v35
    v_and_b32 v13, 0xffff0000, v35
    v_add_f32 v86, v86, v12
    v_add_f32 v87, v87, v13
    v_lshlrev_b32 v12, 16, v36
    v_and_b32 v13, 0xffff0000, v36
    v_add_f32 v80, v80, v12
    v_add_f32 v81, v81, v13
    v_lshlrev_b32 v12, 16, v37
    v_and_b32 v13, 0xffff0000, v37
    v_add_f32 v82, v82, v12
    v_add_f32 v83, v83, v13
    v_lshlrev_b32 v12, 16, v38
    v_and_b32 v13, 0xffff0000, v38
    v_add_f32 v84, v84, v12
    v_add_f32 v85, v85, v13
    v_lshlrev_b32 v12, 16, v39
    v_and_b32 v13, 0xffff0000, v39
    v_add_f32 v86, v86, v12
    v_add_f32 v87, v87, v13
    v_lshlrev_b32 v12, 16, v40
    v_and_b32 v13, 0xffff0000, v40
    v_add_f32 v80, v80, v12
    v_add_f32 v81, v81, v13
    v_lshlrev_b32 v12, 16, v41
    v_and_b32 v13, 0xffff0000, v41
    v_add_f32 v82, v82, v12
    v_add_f32 v83, v83, v13
    v_lshlrev_b32 v12, 16, v42
    v_and_b32 v13, 0xffff0000, v42
    v_add_f32 v84, v84, v12
    v_add_f32 v85, v85, v13
    v_lshlrev_b32 v12, 16, v43
    v_and_b32 v13, 0xffff0000, v43
    v_add_f32 v86, v86, v12
    v_add_f32 v87, v87, v13
    v_lshlrev_b32 v12, 16, v44
    v_and_b32 v13, 0xffff0000, v44
    v_add_f32 v80, v80, v12
    v_add_f32 v81, v81, v13
    v_lshlrev_b32 v12, 16, v45
    v_and_b32 v13, 0xffff0000, v45
    v_add_f32 v82, v82, v12
    v_add_f32 v83, v83, v13
    v_lshlrev_b32 v12, 16, v46
    v_and_b32 v13, 0xffff0000, v46
    v_add_f32 v84, v84, v12
    v_add_f32 v85, v85, v13
    v_lshlrev_b32 v12, 16, v47
    v_and_b32 v13, 0xffff0000, v47
    v_add_f32 v86, v86, v12
    v_add_f32 v87, v87, v13
    v_lshlrev_b32 v12, 16, v48
    v_and_b32 v13, 0xffff0000, v48
    v_add_f32 v80, v80, v12
    v_add_f32 v81, v81, v13
    v_lshlrev_b32 v12, 16, v49
    v_and_b32 v13, 0xffff0000, v49
    v_add_f32 v82, v82, v12
    v_add_f32 v83, v83, v13
    v_lshlrev_b32 v12, 16, v50
    v_and_b32 v13, 0xffff0000, v50
    v_add_f32 v84, v84, v12
    v_add_f32 v85, v85, v13
    v_lshlrev_b32 v12, 16, v51
    v_and_b32 v13, 0xffff0000, v51
    v_add_f32 v86, v86, v12
    v_add_f32 v87, v87, v13
    v_lshlrev_b32 v12, 16, v52
    v_and_b32 v13, 0xffff0000, v52
    v_add_f32 v80, v80, v12
    v_add_f32 v81, v81, v13
    v_lshlrev_b32 v12, 16, v53
    v_and_b32 v13, 0xffff0000, v53
    v_add_f32 v82, v82, v12
    v_add_f32 v83, v83, v13
    v_lshlrev_b32 v12, 16, v54
    v_and_b32 v13, 0xffff0000, v54
    v_add_f32 v84, v84, v12
    v_add_f32 v85, v85, v13
    v_lshlrev_b32 v12, 16, v55
    v_and_b32 v13, 0xffff0000, v55
    v_add_f32 v86, v86, v12
    v_add_f32 v87, v87, v13
    v_lshlrev_b32 v12, 16, v56
    v_and_b32 v13, 0xffff0000, v56
    v_add_f32 v80, v80, v12
    v_add_f32 v81, v81, v13
    v_lshlrev_b32 v12, 16, v57
    v_and_b32 v13, 0xffff0000, v57
    v_add_f32 v82, v82, v12
    v_add_f32 v83, v83, v13
    v_lshlrev_b32 v12, 16, v58
    v_and_b32 v13, 0xffff0000, v58
    v_add_f32 v84, v84, v12
    v_add_f32 v85, v85, v13
    v_lshlrev_b32 v12, 16, v59
    v_and_b32 v13, 0xffff0000, v59
    v_add_f32 v86, v86, v12
    v_add_f32 v87, v87, v13
    v_lshlrev_b32 v12, 16, v60
    v_and_b32 v13, 0xffff0000, v60
    v_add_f32 v80, v80, v12
    v_add_f32 v81, v81, v13
    v_lshlrev_b32 v12, 16, v61
    v_and_b32 v13, 0xffff0000, v61
    v_add_f32 v82, v82, v12
    v_add_f32 v83, v83, v13
    v_lshlrev_b32 v12, 16, v62
    v_and_b32 v13, 0xffff0000, v62
    v_add_f32 v84, v84, v12
    v_add_f32 v85, v85, v13
    v_lshlrev_b32 v12, 16, v63
    v_and_b32 v13, 0xffff0000, v63
    v_add_f32 v86, v86, v12
    v_add_f32 v87, v87, v13
    v_lshlrev_b32 v12, 16, v64
    v_and_b32 v13, 0xffff0000, v64
    v_add_f32 v80, v80, v12
    v_add_f32 v81, v81, v13
    v_lshlrev_b32 v12, 16, v65
    v_and_b32 v13, 0xffff0000, v65
    v_add_f32 v82, v82, v12
    v_add_f32 v83, v83, v13
    v_lshlrev_b32 v12, 16, v66
    v_and_b32 v13, 0xffff0000, v66
    v_add_f32 v84, v84, v12
    v_add_f32 v85, v85, v13
    v_lshlrev_b32 v12, 16, v67
    v_and_b32 v13, 0xffff0000, v67
    v_add_f32 v86, v86, v12
    v_add_f32 v87, v87, v13
    v_lshlrev_b32 v12, 16, v68
    v_and_b32 v13, 0xffff0000, v68
    v_add_f32 v80, v80, v12
    v_add_f32 v81, v81, v13
    v_lshlrev_b32 v12, 16, v69
    v_and_b32 v13, 0xffff0000, v69
    v_add_f32 v82, v82, v12
    v_add_f32 v83, v83, v13
    v_lshlrev_b32 v12, 16, v70
    v_and_b32 v13, 0xffff0000, v70
    v_add_f32 v84, v84, v12
    v_add_f32 v85, v85, v13
    v_lshlrev_b32 v12, 16, v71
    v_and_b32 v13, 0xffff0000, v71
    v_add_f32 v86, v86, v12
    v_add_f32 v87, v87, v13
    v_lshlrev_b32 v12, 16, v72
    v_and_b32 v13, 0xffff0000, v72
    v_add_f32 v80, v80, v12
    v_add_f32 v81, v81, v13
    v_lshlrev_b32 v12, 16, v73
    v_and_b32 v13, 0xffff0000, v73
    v_add_f32 v82, v82, v12
    v_add_f32 v83, v83, v13
    v_lshlrev_b32 v12, 16, v74
    v_and_b32 v13, 0xffff0000, v74
    v_add_f32 v84, v84, v12
    v_add_f32 v85, v85, v13
    v_lshlrev_b32 v12, 16, v75
    v_and_b32 v13, 0xffff0000, v75
    v_add_f32 v86, v86, v12
    v_add_f32 v87, v87, v13
    v_lshlrev_b32 v12, 16, v76
    v_and_b32 v13, 0xffff0000, v76
    v_add_f32 v80, v80, v12
    v_add_f32 v81, v81, v13
    v_lshlrev_b32 v12, 16, v77
    v_and_b32 v13, 0xffff0000, v77
    v_add_f32 v82, v82, v12
    v_add_f32 v83, v83, v13
    v_lshlrev_b32 v12, 16, v78
    v_and_b32 v13, 0xffff0000, v78
    v_add_f32 v84, v84, v12
    v_add_f32 v85, v85, v13
    v_lshlrev_b32 v12, 16, v79
    v_and_b32 v13, 0xffff0000, v79
    v_add_f32 v86, v86, v12
    v_add_f32 v87, v87, v13
    v_lshlrev_b32 v12, 9, v7
    v_lshlrev_b32 v13, 1, v8
    v_add_u32 v12, v12, v13
    v_add_u32 v12, 55360, v12
    ds_write_b128 v12, v[80:83]
    ds_write_b128 v12, v[84:87] offset:16
    v_and_b32 v13, 127, v0
    v_lshlrev_b32 v13, 2, v13
    v_add_u32 v14, 55360, v13
    s_waitcnt lgkmcnt(0)
    s_barrier
    s_cmp_ge_u32 s3, 2
    s_cbranch_scc1 CS_DONE
    ds_read_b32 v16, v14 offset:0
    ds_read_b32 v17, v14 offset:512
    ds_read_b32 v18, v14 offset:1024
    ds_read_b32 v19, v14 offset:1536
    ds_read_b32 v20, v14 offset:2048
    ds_read_b32 v21, v14 offset:2560
    ds_read_b32 v22, v14 offset:3072
    ds_read_b32 v23, v14 offset:3584
    ds_read_b32 v24, v14 offset:4096
    ds_read_b32 v25, v14 offset:4608
    ds_read_b32 v26, v14 offset:5120
    ds_read_b32 v27, v14 offset:5632
    ds_read_b32 v28, v14 offset:6144
    ds_read_b32 v29, v14 offset:6656
    ds_read_b32 v30, v14 offset:7168
    ds_read_b32 v31, v14 offset:7680
    ds_read_b32 v32, v14 offset:8192
    ds_read_b32 v33, v14 offset:8704
    ds_read_b32 v34, v14 offset:9216
    ds_read_b32 v35, v14 offset:9728
    ds_read_b32 v36, v14 offset:10240
    ds_read_b32 v37, v14 offset:10752
    ds_read_b32 v38, v14 offset:11264
    ds_read_b32 v39, v14 offset:11776
    ds_read_b32 v40, v14 offset:12288
    ds_read_b32 v41, v14 offset:12800
    ds_read_b32 v42, v14 offset:13312
    ds_read_b32 v43, v14 offset:13824
    ds_read_b32 v44, v14 offset:14336
    ds_read_b32 v45, v14 offset:14848
    ds_read_b32 v46, v14 offset:15360
    ds_read_b32 v47, v14 offset:15872
    s_waitcnt lgkmcnt(0)
    v_add_f32 v16, v16, v32
    v_add_f32 v17, v17, v33
    v_add_f32 v18, v18, v34
    v_add_f32 v19, v19, v35
    v_add_f32 v20, v20, v36
    v_add_f32 v21, v21, v37
    v_add_f32 v22, v22, v38
    v_add_f32 v23, v23, v39
    v_add_f32 v24, v24, v40
    v_add_f32 v25, v25, v41
    v_add_f32 v26, v26, v42
    v_add_f32 v27, v27, v43
    v_add_f32 v28, v28, v44
    v_add_f32 v29, v29, v45
    v_add_f32 v30, v30, v46
    v_add_f32 v31, v31, v47
    v_add_f32 v16, v16, v24
    v_add_f32 v17, v17, v25
    v_add_f32 v18, v18, v26
    v_add_f32 v19, v19, v27
    v_add_f32 v20, v20, v28
    v_add_f32 v21, v21, v29
    v_add_f32 v22, v22, v30
    v_add_f32 v23, v23, v31
    v_add_f32 v16, v16, v20
    v_add_f32 v17, v17, v21
    v_add_f32 v18, v18, v22
    v_add_f32 v19, v19, v23
    v_add_f32 v16, v16, v18
    v_add_f32 v17, v17, v19
    v_add_f32 v16, v16, v17
    s_add_u32 s44, s22, 65536
    s_addc_u32 s45, s23, 0
    s_lshl_b32 s41, s38, 9
    v_add_u32 v13, s41, v13
    v_add_u32 v14, 7168, v13
    v_lshlrev_b32 v11, 16, v11
    global_store_dword v13, v16, s[44:45] sc1
    global_store_dword v14, v11, s[44:45] sc1
CS_DONE:
    s_lshl_b32 s55, s38, 2
    s_add_u32 s55, s55, 6676480
    v_mov_b32 v4, 0
    global_load_dword v117, v4, s[20:21] sc1
    s_branch M_CONV
M_NOROLE2:
    s_waitcnt vmcnt(0)
M_CONV:
    s_lshr_b32 s24, s3, 2
    s_lshl_b32 s25, s2, 1
    s_add_u32 s25, s25, s24
    s_and_b32 s26, s3, 3
    s_mul_i32 s27, s24, 40880
    v_and_b32 v3, 255, v0
    v_and_b32 v5, 31, v1
    v_lshlrev_b32 v5, 4, v5
    s_waitcnt lgkmcnt(0)
    s_mov_b32 s35, s52
    s_mov_b32 s36, s53
    s_add_u32 s12, s22, 2097152
    s_addc_u32 s13, s23, 0
    s_mov_b32 s14, 2097152
    s_mov_b32 s15, 0x00020000
    s_add_u32 s16, s22, 10485760
    s_addc_u32 s17, s23, 0
    s_mov_b32 s18, 2097152
    s_mov_b32 s19, 0x00020000
    v_lshrrev_b32 v116, 1, v3
    v_lshlrev_b32 v116, 14, v116
    v_and_b32 v8, 1, v3
    v_lshlrev_b32 v8, 4, v8
    v_add_u32 v116, v116, v8
    s_lshl_b32 s54, s25, 5
    s_min_u32 s37, s3, 5
    s_lshl_b32 s37, s37, 9
    s_add_u32 s37, s37, 52288
    v_add_u32 v56, s37, v5
    s_lshr_b32 s31, s3, 2
    s_and_b32 s30, s3, 3
    s_mov_b32 s40, 0
    s_mov_b32 s41, 0x41800000
    s_mov_b32 s42, 0
    s_mov_b32 s43, 0x3f800000
    s_cmp_eq_u32 s30, 1
    s_cselect_b32 s40, 0x43800000, s40
    s_cselect_b32 s42, 0x41000000, s42
    s_cmp_eq_u32 s30, 2
    s_cselect_b32 s40, 0x44000000, s40
    s_cmp_eq_u32 s30, 3
    s_cselect_b32 s40, 0x44c00000, s40
    s_cselect_b32 s42, 0x42000000, s42
    s_cmp_ge_u32 s30, 2
    s_cselect_b32 s41, 0x42800000, s41
    s_cselect_b32 s43, 0x40800000, s43
    s_mul_i32 s32, s31, 26112
    s_mul_i32 s28, s30, 4352
    s_add_u32 s28, s28, s32
    s_mul_i32 s29, s30, 2176
    s_add_u32 s29, s29, 17408
    s_add_u32 s29, s29, s32
    v_lshlrev_b32 v6, 2, v1
    v_add_u32 v7, s29, v6
    v_add_u32 v6, s28, v6
    v_and_b32 v8, 15, v1
    v_lshrrev_b32 v9, 4, v1
    v_mul_u32_u24 v8, 272, v8
    v_lshlrev_b32 v9, 4, v9
    v_add_u32 v8, v8, v9
    s_lshr_b32 s33, s30, 1
    s_mul_i32 s33, s33, 4352
    s_add_u32 s33, s33, 17408
    s_add_u32 s33, s33, s32
    v_add_u32 v9, s33, v8
    v_add_u32 v8, s28, v8
    v_and_b32 v10, 15, v1
    v_lshrrev_b32 v11, 4, v1
    v_lshlrev_b32 v11, 8, v11
    v_lshlrev_b32 v10, 2, v10
    v_add_u32 v10, v10, v11
    s_lshl_b32 s28, s30, 10
    s_lshl_b32 s29, s31, 12
    s_add_u32 s28, s28, s29
    s_add_u32 s28, s28, 55360
    v_add_u32 v10, s28, v10
    v_lshlrev_b32 v11, 2, v0
    v_sub_u32 v11, 2047, v11
    v_subrev_u32 v16, 0, v11
    v_cvt_f32_u32 v16, v16
    v_cvt_pk_bf16_f32 v16, v16, v16
    v_lshlrev_b32 v16, 16, v16
    v_cvt_u32_f32 v16, v16
    v_subrev_u32 v12, 512, v16
    v_lshrrev_b32 v12, 2, v12
    v_add_u32 v12, 512, v12
    v_cmp_gt_u32 vcc, 512, v16
    s_nop 1
    v_cndmask_b32 v16, v12, v16, vcc
    v_lshlrev_b32 v16, 2, v16
    v_add_u32 v16, 55360, v16
    v_subrev_u32 v17, 1, v11
    v_cvt_f32_u32 v17, v17
    v_cvt_pk_bf16_f32 v17, v17, v17
    v_lshlrev_b32 v17, 16, v17
    v_cvt_u32_f32 v17, v17
    v_subrev_u32 v12, 512, v17
    v_lshrrev_b32 v12, 2, v12
    v_add_u32 v12, 512, v12
    v_cmp_gt_u32 vcc, 512, v17
    s_nop 1
    v_cndmask_b32 v17, v12, v17, vcc
    v_lshlrev_b32 v17, 2, v17
    v_add_u32 v17, 55360, v17
    v_subrev_u32 v18, 2, v11
    v_cvt_f32_u32 v18, v18
    v_cvt_pk_bf16_f32 v18, v18, v18
    v_lshlrev_b32 v18, 16, v18
    v_cvt_u32_f32 v18, v18
    v_subrev_u32 v12, 512, v18
    v_lshrrev_b32 v12, 2, v12
    v_add_u32 v12, 512, v12
    v_cmp_gt_u32 vcc, 512, v18
    s_nop 1
    v_cndmask_b32 v18, v12, v18, vcc
    v_lshlrev_b32 v18, 2, v18
    v_add_u32 v18, 55360, v18
    v_subrev_u32 v19, 3, v11
    v_cvt_f32_u32 v19, v19
    v_cvt_pk_bf16_f32 v19, v19, v19
    v_lshlrev_b32 v19, 16, v19
    v_cvt_u32_f32 v19, v19
    v_subrev_u32 v12, 512, v19
    v_lshrrev_b32 v12, 2, v12
    v_add_u32 v12, 512, v12
    v_cmp_gt_u32 vcc, 512, v19
    s_nop 1
    v_cndmask_b32 v19, v12, v19, vcc
    v_lshlrev_b32 v19, 2, v19
    v_add_u32 v19, 55360, v19
    ds_write_b128 v56, v[112:115]
    v_lshlrev_b32 v12, 1, v1
    s_lshl_b32 s28, s31, 7
    s_add_u32 s28, s28, 52288
    v_add_u32 v12, s28, v12
    s_waitcnt vmcnt(0) lgkmcnt(0)
    s_barrier
    s_cmp_lg_u32 s3, 7
    s_cbranch_scc1 KG_NOSIG
    s_cmp_eq_u32 s55, 0
    s_cbranch_scc1 KG_NOSIG
    v_cmp_eq_u32 vcc, 0, v117
    s_nop 3
    s_cmp_eq_u64 vcc, 0
    s_cbranch_scc1 KG_ZOK
    v_mov_b32 v118, 0
WZ_kg:
    global_load_dword v117, v118, s[20:21] sc1
    s_waitcnt vmcnt(0)
    v_cmp_eq_u32 vcc, 0, v117
    s_nop 3
    s_cmp_eq_u64 vcc, 0
    s_cbranch_scc1 WZD_kg
    s_sleep 8
    s_branch WZ_kg
WZD_kg:
KG_ZOK:
    v_mov_b32 v117, s55
    v_mov_b32 v118, 0x01010101
    v_cmp_eq_u32 vcc, 0, v1
    s_and_saveexec_b64 s[50:51], vcc
    global_store_dword v117, v118, s[22:23] sc1
    s_mov_b64 exec, s[50:51]
KG_NOSIG:
    s_setprio 0
    ds_read_u16 v52, v12 offset:0
    ds_read_u16 v53, v12 offset:512
    ds_read_u16 v54, v12 offset:1024
    ds_read_u16 v55, v12 offset:1536
    ds_read_u16 v56, v12 offset:2048
    ds_read_u16 v57, v12 offset:2560
    ds_read_u16 v60, v12 offset:256
    ds_read_u16 v61, v12 offset:768
    ds_read_u16 v62, v12 offset:1280
    ds_read_u16 v63, v12 offset:1792
    ds_read_u16 v64, v12 offset:2304
    ds_read_u16 v65, v12 offset:2816
    s_and_b32 s28, s35, 0xffff
    s_lshr_b32 s29, s35, 16
    v_mov_b32 v58, s28
    v_mov_b32 v66, s29
    s_waitcnt lgkmcnt(0)
    v_lshlrev_b32 v5, 16, v58
    v_mul_f32 v5, 0x3fb8aa3b, v5
    v_exp_f32 v5, v5
    s_nop 0
    v_cvt_pk_bf16_f32 v5, v5, v5
    v_lshlrev_b32 v5, 16, v5
    v_lshlrev_b32 v52, 16, v52
    v_lshlrev_b32 v53, 16, v53
    v_lshlrev_b32 v54, 16, v54
    v_lshlrev_b32 v55, 16, v55
    v_lshlrev_b32 v56, 16, v56
    v_lshlrev_b32 v57, 16, v57
    v_mul_f32 v24, v5, v52
    v_mul_f32 v25, v5, v53
    v_mul_f32 v24, 0x3fb8aa3b, v24
    v_mul_f32 v25, 0x3e22f983, v25
    v_sub_f32 v26, 0, v25
    v_mul_f32 v27, v5, v54
    v_mul_f32 v28, v5, v55
    v_mul_f32 v29, v56, v27
    v_mul_f32 v30, v56, v28
    v_fma_f32 v29, -v57, v28, v29
    v_fma_f32 v30, v57, v27, v30
    v_max_f32 v31, abs(v29), abs(v30)
    v_max_f32 v31, 0x0da24260, v31
    v_mul_f32 v40, s40, v24
    v_mul_f32 v41, s40, v26
    v_exp_f32 v40, v40
    v_fract_f32 v41, v41
    v_cos_f32 v32, v41
    v_sin_f32 v33, v41
    s_nop 0
    v_mul_f32 v32, v40, v32
    v_mul_f32 v33, v40, v33
    v_max_f32_dpp v31, v31, v31 quad_perm:[1,0,3,2]
    v_mul_f32 v40, s41, v24
    v_mul_f32 v41, s41, v26
    v_exp_f32 v40, v40
    v_fract_f32 v41, v41
    v_cos_f32 v34, v41
    v_sin_f32 v35, v41
    s_nop 0
    v_mul_f32 v34, v40, v34
    v_mul_f32 v35, v40, v35
    v_max_f32_dpp v31, v31, v31 quad_perm:[2,3,0,1]
    v_mul_f32 v40, s42, v24
    v_mul_f32 v41, s42, v25
    v_exp_f32 v40, v40
    v_fract_f32 v41, v41
    v_cos_f32 v44, v41
    v_sin_f32 v45, v41
    s_nop 0
    v_mul_f32 v44, v40, v44
    v_mul_f32 v45, v40, v45
    v_max_f32_dpp v31, v31, v31 row_half_mirror
    v_mul_f32 v40, s43, v24
    v_mul_f32 v41, s43, v25
    v_exp_f32 v40, v40
    v_fract_f32 v41, v41
    v_cos_f32 v46, v41
    v_sin_f32 v47, v41
    s_nop 0
    v_mul_f32 v46, v40, v46
    v_mul_f32 v47, v40, v47
    v_max_f32_dpp v31, v31, v31 row_mirror
    s_nop 1
    v_max_f32_dpp v31, v31, v31 row_bcast:15 row_mask:0xa
    s_nop 1
    v_max_f32_dpp v31, v31, v31 row_bcast:31 row_mask:0xc
    s_nop 1
    v_readlane_b32 s34, v31, 63
    s_nop 3
    v_mov_b32 v31, s34
    v_rcp_f32 v40, v31
    s_lshl_b32 s34, s31, 2
    s_add_u32 s34, s34, 52224
    v_mov_b32 v41, s34
    ds_write_b32 v41, v31
    v_mul_f32 v29, v29, v40
    v_mul_f32 v30, v30, v40
    v_sub_f32 v30, 0, v30
    v_mov_b32 v68, 0
    v_mov_b32 v69, 0
    v_mov_b32 v70, 0
    v_mov_b32 v71, 0
    v_mul_f32 v36, v29, v32
    v_mul_f32 v37, v29, v33
    v_fma_f32 v36, -v30, v33, v36
    v_fma_f32 v37, v30, v32, v37
    v_cvt_pk_f16_f32 v42, v36, v37
    ds_write_b32 v6, v42 offset:0
    v_cvt_pk_f16_f32 v50, v44, v45
    ds_write_b32 v7, v50 offset:0
    v_mul_f32 v38, v36, v34
    v_mul_f32 v39, v36, v35
    v_fma_f32 v38, -v37, v35, v38
    v_fma_f32 v39, v37, v34, v39
    v_mul_f32 v48, v44, v46
    v_mul_f32 v49, v44, v47
    v_fma_f32 v48, -v45, v47, v48
    v_fma_f32 v49, v45, v46, v49
    v_cvt_pk_f16_f32 v43, v38, v39
    ds_write_b32 v6, v43 offset:272
    v_cvt_pk_f16_f32 v51, v48, v49
    ds_write_b32 v7, v51 offset:272
    v_mul_f32 v36, v38, v34
    v_mul_f32 v37, v38, v35
    v_fma_f32 v36, -v39, v35, v36
    v_fma_f32 v37, v39, v34, v37
    v_mul_f32 v44, v48, v46
    v_mul_f32 v45, v48, v47
    v_fma_f32 v44, -v49, v47, v44
    v_fma_f32 v45, v49, v46, v45
    v_cvt_pk_f16_f32 v42, v36, v37
    ds_write_b32 v6, v42 offset:544
    v_cvt_pk_f16_f32 v50, v44, v45
    ds_write_b32 v7, v50 offset:544
    v_mul_f32 v38, v36, v34
    v_mul_f32 v39, v36, v35
    v_fma_f32 v38, -v37, v35, v38
    v_fma_f32 v39, v37, v34, v39
    v_mul_f32 v48, v44, v46
    v_mul_f32 v49, v44, v47
    v_fma_f32 v48, -v45, v47, v48
    v_fma_f32 v49, v45, v46, v49
    v_cvt_pk_f16_f32 v43, v38, v39
    ds_write_b32 v6, v43 offset:816
    v_cvt_pk_f16_f32 v51, v48, v49
    ds_write_b32 v7, v51 offset:816
    v_mul_f32 v36, v38, v34
    v_mul_f32 v37, v38, v35
    v_fma_f32 v36, -v39, v35, v36
    v_fma_f32 v37, v39, v34, v37
    v_mul_f32 v44, v48, v46
    v_mul_f32 v45, v48, v47
    v_fma_f32 v44, -v49, v47, v44
    v_fma_f32 v45, v49, v46, v45
    v_cvt_pk_f16_f32 v42, v36, v37
    ds_write_b32 v6, v42 offset:1088
    v_cvt_pk_f16_f32 v50, v44, v45
    ds_write_b32 v7, v50 offset:1088
    v_mul_f32 v38, v36, v34
    v_mul_f32 v39, v36, v35
    v_fma_f32 v38, -v37, v35, v38
    v_fma_f32 v39, v37, v34, v39
    v_mul_f32 v48, v44, v46
    v_mul_f32 v49, v44, v47
    v_fma_f32 v48, -v45, v47, v48
    v_fma_f32 v49, v45, v46, v49
    v_cvt_pk_f16_f32 v43, v38, v39
    ds_write_b32 v6, v43 offset:1360
    v_cvt_pk_f16_f32 v51, v48, v49
    ds_write_b32 v7, v51 offset:1360
    v_mul_f32 v36, v38, v34
    v_mul_f32 v37, v38, v35
    v_fma_f32 v36, -v39, v35, v36
    v_fma_f32 v37, v39, v34, v37
    v_mul_f32 v44, v48, v46
    v_mul_f32 v45, v48, v47
    v_fma_f32 v44, -v49, v47, v44
    v_fma_f32 v45, v49, v46, v45
    v_cvt_pk_f16_f32 v42, v36, v37
    ds_write_b32 v6, v42 offset:1632
    v_cvt_pk_f16_f32 v50, v44, v45
    ds_write_b32 v7, v50 offset:1632
    v_mul_f32 v38, v36, v34
    v_mul_f32 v39, v36, v35
    v_fma_f32 v38, -v37, v35, v38
    v_fma_f32 v39, v37, v34, v39
    v_mul_f32 v48, v44, v46
    v_mul_f32 v49, v44, v47
    v_fma_f32 v48, -v45, v47, v48
    v_fma_f32 v49, v45, v46, v49
    v_cvt_pk_f16_f32 v43, v38, v39
    ds_write_b32 v6, v43 offset:1904
    v_cvt_pk_f16_f32 v51, v48, v49
    ds_write_b32 v7, v51 offset:1904
    v_mul_f32 v36, v38, v34
    v_mul_f32 v37, v38, v35
    v_fma_f32 v36, -v39, v35, v36
    v_fma_f32 v37, v39, v34, v37
    v_cvt_pk_f16_f32 v42, v36, v37
    ds_write_b32 v6, v42 offset:2176
    v_mul_f32 v38, v36, v34
    v_mul_f32 v39, v36, v35
    v_fma_f32 v38, -v37, v35, v38
    v_fma_f32 v39, v37, v34, v39
    v_cvt_pk_f16_f32 v43, v38, v39
    ds_write_b32 v6, v43 offset:2448
    v_mul_f32 v36, v38, v34
    v_mul_f32 v37, v38, v35
    v_fma_f32 v36, -v39, v35, v36
    v_fma_f32 v37, v39, v34, v37
    v_cvt_pk_f16_f32 v42, v36, v37
    ds_write_b32 v6, v42 offset:2720
    v_mul_f32 v38, v36, v34
    v_mul_f32 v39, v36, v35
    v_fma_f32 v38, -v37, v35, v38
    v_fma_f32 v39, v37, v34, v39
    v_cvt_pk_f16_f32 v43, v38, v39
    ds_write_b32 v6, v43 offset:2992
    v_mul_f32 v36, v38, v34
    v_mul_f32 v37, v38, v35
    v_fma_f32 v36, -v39, v35, v36
    v_fma_f32 v37, v39, v34, v37
    v_cvt_pk_f16_f32 v42, v36, v37
    ds_write_b32 v6, v42 offset:3264
    v_mul_f32 v38, v36, v34
    v_mul_f32 v39, v36, v35
    v_fma_f32 v38, -v37, v35, v38
    v_fma_f32 v39, v37, v34, v39
    v_cvt_pk_f16_f32 v43, v38, v39
    ds_write_b32 v6, v43 offset:3536
    v_mul_f32 v36, v38, v34
    v_mul_f32 v37, v38, v35
    v_fma_f32 v36, -v39, v35, v36
    v_fma_f32 v37, v39, v34, v37
    v_cvt_pk_f16_f32 v42, v36, v37
    ds_write_b32 v6, v42 offset:3808
    v_mul_f32 v38, v36, v34
    v_mul_f32 v39, v36, v35
    v_fma_f32 v38, -v37, v35, v38
    v_fma_f32 v39, v37, v34, v39
    v_cvt_pk_f16_f32 v43, v38, v39
    ds_write_b32 v6, v43 offset:4080
    s_waitcnt lgkmcnt(0)
    s_barrier
    ds_read_b128 v[72:75], v8 offset:0
    ds_read_b128 v[76:79], v9 offset:0
    ds_read_b128 v[80:83], v8 offset:64
    ds_read_b128 v[84:87], v9 offset:64
    ds_read_b128 v[88:91], v8 offset:128
    ds_read_b128 v[92:95], v9 offset:128
    ds_read_b128 v[96:99], v8 offset:192
    ds_read_b128 v[100:103], v9 offset:192
    v_mov_b32 v12, 52224
    ds_read_b64 v[14:15], v12
    s_waitcnt lgkmcnt(7)
    v_mfma_f32_16x16x32_f16 v[68:71], v[72:75], v[76:79], v[68:71]
    s_waitcnt lgkmcnt(5)
    v_mfma_f32_16x16x32_f16 v[68:71], v[80:83], v[84:87], v[68:71]
    s_waitcnt lgkmcnt(3)
    v_mfma_f32_16x16x32_f16 v[68:71], v[88:91], v[92:95], v[68:71]
    s_waitcnt lgkmcnt(1)
    v_mfma_f32_16x16x32_f16 v[68:71], v[96:99], v[100:103], v[68:71]
    s_waitcnt lgkmcnt(0)
    v_add_f32 v104, v14, v15
    v_rcp_f32 v106, v104
    s_nop 6
    v_mul_f32 v68, v68, v31
    v_mul_f32 v69, v69, v31
    v_mul_f32 v70, v70, v31
    v_mul_f32 v71, v71, v31
    ds_write_b32 v10, v68 offset:0
    ds_write_b32 v10, v69 offset:64
    ds_write_b32 v10, v70 offset:128
    ds_write_b32 v10, v71 offset:192
    v_lshlrev_b32 v5, 16, v66
    v_mul_f32 v5, 0x3fb8aa3b, v5
    v_exp_f32 v5, v5
    s_nop 0
    v_cvt_pk_bf16_f32 v5, v5, v5
    v_lshlrev_b32 v5, 16, v5
    v_lshlrev_b32 v60, 16, v60
    v_lshlrev_b32 v61, 16, v61
    v_lshlrev_b32 v62, 16, v62
    v_lshlrev_b32 v63, 16, v63
    v_lshlrev_b32 v64, 16, v64
    v_lshlrev_b32 v65, 16, v65
    v_mul_f32 v24, v5, v60
    v_mul_f32 v25, v5, v61
    v_mul_f32 v24, 0x3fb8aa3b, v24
    v_mul_f32 v25, 0x3e22f983, v25
    v_sub_f32 v26, 0, v25
    v_mul_f32 v27, v5, v62
    v_mul_f32 v28, v5, v63
    v_mul_f32 v29, v64, v27
    v_mul_f32 v30, v64, v28
    v_fma_f32 v29, -v65, v28, v29
    v_fma_f32 v30, v65, v27, v30
    v_max_f32 v31, abs(v29), abs(v30)
    v_max_f32 v31, 0x0da24260, v31
    v_mul_f32 v40, s40, v24
    v_mul_f32 v41, s40, v26
    v_exp_f32 v40, v40
    v_fract_f32 v41, v41
    v_cos_f32 v32, v41
    v_sin_f32 v33, v41
    s_nop 0
    v_mul_f32 v32, v40, v32
    v_mul_f32 v33, v40, v33
    v_max_f32_dpp v31, v31, v31 quad_perm:[1,0,3,2]
    v_mul_f32 v40, s41, v24
    v_mul_f32 v41, s41, v26
    v_exp_f32 v40, v40
    v_fract_f32 v41, v41
    v_cos_f32 v34, v41
    v_sin_f32 v35, v41
    s_nop 0
    v_mul_f32 v34, v40, v34
    v_mul_f32 v35, v40, v35
    v_max_f32_dpp v31, v31, v31 quad_perm:[2,3,0,1]
    v_mul_f32 v40, s42, v24
    v_mul_f32 v41, s42, v25
    v_exp_f32 v40, v40
    v_fract_f32 v41, v41
    v_cos_f32 v44, v41
    v_sin_f32 v45, v41
    s_nop 0
    v_mul_f32 v44, v40, v44
    v_mul_f32 v45, v40, v45
    v_max_f32_dpp v31, v31, v31 row_half_mirror
    v_mul_f32 v40, s43, v24
    v_mul_f32 v41, s43, v25
    v_exp_f32 v40, v40
    v_fract_f32 v41, v41
    v_cos_f32 v46, v41
    v_sin_f32 v47, v41
    s_nop 0
    v_mul_f32 v46, v40, v46
    v_mul_f32 v47, v40, v47
    v_max_f32_dpp v31, v31, v31 row_mirror
    s_nop 1
    v_max_f32_dpp v31, v31, v31 row_bcast:15 row_mask:0xa
    s_nop 1
    v_max_f32_dpp v31, v31, v31 row_bcast:31 row_mask:0xc
    s_nop 1
    v_readlane_b32 s34, v31, 63
    s_nop 3
    v_mov_b32 v31, s34
    v_rcp_f32 v40, v31
    s_lshl_b32 s34, s31, 2
    s_add_u32 s34, s34, 52232
    v_mov_b32 v41, s34
    ds_write_b32 v41, v31
    v_mul_f32 v29, v29, v40
    v_mul_f32 v30, v30, v40
    v_sub_f32 v30, 0, v30
    v_mov_b32 v68, 0
    v_mov_b32 v69, 0
    v_mov_b32 v70, 0
    v_mov_b32 v71, 0
    v_mul_f32 v36, v29, v32
    v_mul_f32 v37, v29, v33
    v_fma_f32 v36, -v30, v33, v36
    v_fma_f32 v37, v30, v32, v37
    s_barrier
    v_cvt_pk_f16_f32 v42, v36, v37
    ds_write_b32 v6, v42 offset:0
    v_cvt_pk_f16_f32 v50, v44, v45
    ds_write_b32 v7, v50 offset:0
    v_mul_f32 v38, v36, v34
    v_mul_f32 v39, v36, v35
    v_fma_f32 v38, -v37, v35, v38
    v_fma_f32 v39, v37, v34, v39
    v_mul_f32 v48, v44, v46
    v_mul_f32 v49, v44, v47
    v_fma_f32 v48, -v45, v47, v48
    v_fma_f32 v49, v45, v46, v49
    v_cvt_pk_f16_f32 v43, v38, v39
    ds_write_b32 v6, v43 offset:272
    v_cvt_pk_f16_f32 v51, v48, v49
    ds_write_b32 v7, v51 offset:272
    v_mul_f32 v36, v38, v34
    v_mul_f32 v37, v38, v35
    v_fma_f32 v36, -v39, v35, v36
    v_fma_f32 v37, v39, v34, v37
    v_mul_f32 v44, v48, v46
    v_mul_f32 v45, v48, v47
    v_fma_f32 v44, -v49, v47, v44
    v_fma_f32 v45, v49, v46, v45
    v_cvt_pk_f16_f32 v42, v36, v37
    ds_write_b32 v6, v42 offset:544
    v_cvt_pk_f16_f32 v50, v44, v45
    ds_write_b32 v7, v50 offset:544
    v_mul_f32 v38, v36, v34
    v_mul_f32 v39, v36, v35
    v_fma_f32 v38, -v37, v35, v38
    v_fma_f32 v39, v37, v34, v39
    v_mul_f32 v48, v44, v46
    v_mul_f32 v49, v44, v47
    v_fma_f32 v48, -v45, v47, v48
    v_fma_f32 v49, v45, v46, v49
    v_cvt_pk_f16_f32 v43, v38, v39
    ds_write_b32 v6, v43 offset:816
    v_cvt_pk_f16_f32 v51, v48, v49
    ds_write_b32 v7, v51 offset:816
    v_mul_f32 v36, v38, v34
    v_mul_f32 v37, v38, v35
    v_fma_f32 v36, -v39, v35, v36
    v_fma_f32 v37, v39, v34, v37
    v_mul_f32 v44, v48, v46
    v_mul_f32 v45, v48, v47
    v_fma_f32 v44, -v49, v47, v44
    v_fma_f32 v45, v49, v46, v45
    v_cvt_pk_f16_f32 v42, v36, v37
    ds_write_b32 v6, v42 offset:1088
    v_cvt_pk_f16_f32 v50, v44, v45
    ds_write_b32 v7, v50 offset:1088
    v_mul_f32 v38, v36, v34
    v_mul_f32 v39, v36, v35
    v_fma_f32 v38, -v37, v35, v38
    v_fma_f32 v39, v37, v34, v39
    v_mul_f32 v48, v44, v46
    v_mul_f32 v49, v44, v47
    v_fma_f32 v48, -v45, v47, v48
    v_fma_f32 v49, v45, v46, v49
    v_cvt_pk_f16_f32 v43, v38, v39
    ds_write_b32 v6, v43 offset:1360
    v_cvt_pk_f16_f32 v51, v48, v49
    ds_write_b32 v7, v51 offset:1360
    v_mul_f32 v36, v38, v34
    v_mul_f32 v37, v38, v35
    v_fma_f32 v36, -v39, v35, v36
    v_fma_f32 v37, v39, v34, v37
    v_mul_f32 v44, v48, v46
    v_mul_f32 v45, v48, v47
    v_fma_f32 v44, -v49, v47, v44
    v_fma_f32 v45, v49, v46, v45
    v_cvt_pk_f16_f32 v42, v36, v37
    ds_write_b32 v6, v42 offset:1632
    v_cvt_pk_f16_f32 v50, v44, v45
    ds_write_b32 v7, v50 offset:1632
    v_mul_f32 v38, v36, v34
    v_mul_f32 v39, v36, v35
    v_fma_f32 v38, -v37, v35, v38
    v_fma_f32 v39, v37, v34, v39
    v_mul_f32 v48, v44, v46
    v_mul_f32 v49, v44, v47
    v_fma_f32 v48, -v45, v47, v48
    v_fma_f32 v49, v45, v46, v49
    v_cvt_pk_f16_f32 v43, v38, v39
    ds_write_b32 v6, v43 offset:1904
    v_cvt_pk_f16_f32 v51, v48, v49
    ds_write_b32 v7, v51 offset:1904
    v_mul_f32 v36, v38, v34
    v_mul_f32 v37, v38, v35
    v_fma_f32 v36, -v39, v35, v36
    v_fma_f32 v37, v39, v34, v37
    v_cvt_pk_f16_f32 v42, v36, v37
    ds_write_b32 v6, v42 offset:2176
    v_mul_f32 v38, v36, v34
    v_mul_f32 v39, v36, v35
    v_fma_f32 v38, -v37, v35, v38
    v_fma_f32 v39, v37, v34, v39
    v_cvt_pk_f16_f32 v43, v38, v39
    ds_write_b32 v6, v43 offset:2448
    v_mul_f32 v36, v38, v34
    v_mul_f32 v37, v38, v35
    v_fma_f32 v36, -v39, v35, v36
    v_fma_f32 v37, v39, v34, v37
    v_cvt_pk_f16_f32 v42, v36, v37
    ds_write_b32 v6, v42 offset:2720
    v_mul_f32 v38, v36, v34
    v_mul_f32 v39, v36, v35
    v_fma_f32 v38, -v37, v35, v38
    v_fma_f32 v39, v37, v34, v39
    v_cvt_pk_f16_f32 v43, v38, v39
    ds_write_b32 v6, v43 offset:2992
    v_mul_f32 v36, v38, v34
    v_mul_f32 v37, v38, v35
    v_fma_f32 v36, -v39, v35, v36
    v_fma_f32 v37, v39, v34, v37
    v_cvt_pk_f16_f32 v42, v36, v37
    ds_write_b32 v6, v42 offset:3264
    v_mul_f32 v38, v36, v34
    v_mul_f32 v39, v36, v35
    v_fma_f32 v38, -v37, v35, v38
    v_fma_f32 v39, v37, v34, v39
    v_cvt_pk_f16_f32 v43, v38, v39
    ds_write_b32 v6, v43 offset:3536
    v_mul_f32 v36, v38, v34
    v_mul_f32 v37, v38, v35
    v_fma_f32 v36, -v39, v35, v36
    v_fma_f32 v37, v39, v34, v37
    v_cvt_pk_f16_f32 v42, v36, v37
    ds_write_b32 v6, v42 offset:3808
    v_mul_f32 v38, v36, v34
    v_mul_f32 v39, v36, v35
    v_fma_f32 v38, -v37, v35, v38
    v_fma_f32 v39, v37, v34, v39
    v_cvt_pk_f16_f32 v43, v38, v39
    ds_write_b32 v6, v43 offset:4080
    s_waitcnt lgkmcnt(0)
    s_barrier
    ds_read_b128 v[72:75], v8 offset:0
    ds_read_b128 v[76:79], v9 offset:0
    ds_read_b128 v[80:83], v8 offset:64
    ds_read_b128 v[84:87], v9 offset:64
    ds_read_b128 v[88:91], v8 offset:128
    ds_read_b128 v[92:95], v9 offset:128
    ds_read_b128 v[96:99], v8 offset:192
    ds_read_b128 v[100:103], v9 offset:192
    v_mov_b32 v12, 52232
    ds_read_b64 v[14:15], v12
    s_waitcnt lgkmcnt(7)
    v_mfma_f32_16x16x32_f16 v[68:71], v[72:75], v[76:79], v[68:71]
    s_waitcnt lgkmcnt(5)
    v_mfma_f32_16x16x32_f16 v[68:71], v[80:83], v[84:87], v[68:71]
    s_waitcnt lgkmcnt(3)
    v_mfma_f32_16x16x32_f16 v[68:71], v[88:91], v[92:95], v[68:71]
    s_waitcnt lgkmcnt(1)
    v_mfma_f32_16x16x32_f16 v[68:71], v[96:99], v[100:103], v[68:71]
    s_waitcnt lgkmcnt(0)
    v_add_f32 v105, v14, v15
    v_rcp_f32 v107, v105
    s_nop 6
    v_mul_f32 v68, v68, v31
    v_mul_f32 v69, v69, v31
    v_mul_f32 v70, v70, v31
    v_mul_f32 v71, v71, v31
    ds_write_b32 v10, v68 offset:8192
    ds_write_b32 v10, v69 offset:8256
    ds_write_b32 v10, v70 offset:8320
    ds_write_b32 v10, v71 offset:8384
    s_cmp_lg_u32 s3, 0
    s_cbranch_scc1 CV_NOPOLL
    v_mov_b32 v21, 0
WZ_cv:
    global_load_dword v20, v21, s[20:21] sc1
    s_waitcnt vmcnt(0)
    v_cmp_eq_u32 vcc, 0, v20
    s_nop 3
    s_cmp_eq_u64 vcc, 0
    s_cbranch_scc1 WZD_cv
    s_sleep 8
    s_branch WZ_cv
WZD_cv:
    s_mov_b32 s48, 6553600
    v_min_u32 v21, 63, v1
    v_lshlrev_b32 v21, 2, v21
    v_add_u32 v21, s48, v21
    s_mov_b32 s49, 0x01010101
POLL_cv:
    global_load_dword v20, v21, s[22:23] sc1
    s_waitcnt vmcnt(0)
    v_cmp_ne_u32 vcc, s49, v20
    s_nop 3
    s_cmp_eq_u64 vcc, 0
    s_cbranch_scc1 POLLD_cv
    s_sleep 8
    s_branch POLL_cv
POLLD_cv:
    s_mov_b32 s48, 6672384
    v_min_u32 v21, 63, v1
    v_lshlrev_b32 v21, 2, v21
    v_add_u32 v21, s48, v21
    s_mov_b32 s49, 0x01010101
POLL_cv2:
    global_load_dword v20, v21, s[22:23] sc1
    s_waitcnt vmcnt(0)
    v_cmp_ne_u32 vcc, s49, v20
    s_nop 3
    s_cmp_eq_u64 vcc, 0
    s_cbranch_scc1 POLLD_cv2
    s_sleep 8
    s_branch POLL_cv2
POLLD_cv2:
CV_NOPOLL:
    s_waitcnt lgkmcnt(0)
    s_barrier
    buffer_load_dwordx4 v[108:111], v116, s[12:15], s54 offen sc1
    ds_read_b32 v20, v16 offset:0
    ds_read_b32 v24, v16 offset:4096
    ds_read_b32 v21, v17 offset:0
    ds_read_b32 v25, v17 offset:4096
    ds_read_b32 v22, v18 offset:0
    ds_read_b32 v26, v18 offset:4096
    ds_read_b32 v23, v19 offset:0
    ds_read_b32 v27, v19 offset:4096
    ds_read_b32 v28, v16 offset:8192
    ds_read_b32 v32, v16 offset:12288
    ds_read_b32 v29, v17 offset:8192
    ds_read_b32 v33, v17 offset:12288
    ds_read_b32 v30, v18 offset:8192
    ds_read_b32 v34, v18 offset:12288
    ds_read_b32 v31, v19 offset:8192
    ds_read_b32 v35, v19 offset:12288
    v_lshlrev_b32 v12, 3, v0
    v_add_u32 v12, 71744, v12
    v_mov_b32 v40, 0
    v_mov_b32 v41, 0
    v_mov_b32 v42, 0
    v_mov_b32 v43, 0
    v_lshlrev_b32 v4, 4, v3
    s_mul_i32 s28, s24, 4160
    s_add_u32 s28, s28, 71744
    v_add_u32 v13, s28, v4
    s_waitcnt lgkmcnt(0)
    v_add_f32 v20, v20, v24
    v_add_f32 v21, v21, v25
    v_add_f32 v22, v22, v26
    v_add_f32 v23, v23, v27
    v_mul_f32 v20, v20, v106
    v_mul_f32 v21, v21, v106
    v_mul_f32 v22, v22, v106
    v_mul_f32 v23, v23, v106
    v_cvt_pk_f16_f32 v36, v20, v21
    v_cvt_pk_f16_f32 v37, v22, v23
    ds_write_b64 v12, v[36:37] offset:0
    v_add_f32 v28, v28, v32
    v_add_f32 v29, v29, v33
    v_add_f32 v30, v30, v34
    v_add_f32 v31, v31, v35
    v_mul_f32 v28, v28, v107
    v_mul_f32 v29, v29, v107
    v_mul_f32 v30, v30, v107
    v_mul_f32 v31, v31, v107
    v_cvt_pk_f16_f32 v38, v28, v29
    v_cvt_pk_f16_f32 v39, v30, v31
    ds_write_b64 v12, v[38:39] offset:4160
    v_cmp_gt_u32 vcc, 8, v0
    s_and_saveexec_b64 s[30:31], vcc
    ds_write_b64 v12, v[40:41] offset:4096
    ds_write_b64 v12, v[40:41] offset:8256
    s_mov_b64 exec, s[30:31]
    s_waitcnt lgkmcnt(0)
    s_barrier
    ds_read_b128 v[64:67], v13
    ds_read_b128 v[68:71], v13 offset:16
    v_lshrrev_b32 v5, 2, v3
    v_and_b32 v6, 3, v3
    v_lshlrev_b32 v6, 4, v6
    v_mul_u32_u24 v5, 4160, v5
    v_add_u32 v5, v5, v6
    v_add_u32 v5, 4096, v5
    v_add_u32 v5, s27, v5
    v_add_u32 v6, s27, v4
    v_lshrrev_b32 v24, 2, v3
    v_and_b32 v25, 3, v3
    v_mul_u32_u24 v24, 80, v24
    v_lshlrev_b32 v25, 4, v25
    v_add_u32 v24, v24, v25
    v_add_u32 v24, s27, v24
    s_waitcnt lgkmcnt(0)
    s_barrier
    v_cmp_gt_u32 vcc, 155, v3
    s_and_saveexec_b64 s[30:31], vcc
    ds_write_b128 v6, v[40:43] offset:33280
    s_mov_b64 exec, s[30:31]
    v_cmp_gt_u32 vcc, 32, v3
    s_and_saveexec_b64 s[30:31], vcc
    ds_write_b128 v5, v[40:43]
    s_mov_b64 exec, s[30:31]
    ds_write_b128 v6, v[64:67]
    ds_write_b128 v6, v[66:69] offset:16640
    v_mov_b32 v74, v65
    v_mov_b32 v75, v66
    v_mov_b32 v76, v67
    v_mov_b32 v77, v68
    v_mov_b32 v78, v69
    v_mov_b32 v79, v70
    v_alignbit_b32 v80, v65, v64, 16
    v_alignbit_b32 v81, v66, v65, 16
    v_alignbit_b32 v82, v67, v66, 16
    v_alignbit_b32 v83, v68, v67, 16
    v_alignbit_b32 v84, v69, v68, 16
    v_alignbit_b32 v85, v70, v69, 16
    v_alignbit_b32 v86, v71, v70, 16
    v_alignbit_b32 v88, v66, v65, 16
    v_alignbit_b32 v89, v67, v66, 16
    v_alignbit_b32 v90, v68, v67, 16
    v_alignbit_b32 v91, v69, v68, 16
    v_alignbit_b32 v92, v70, v69, 16
    v_alignbit_b32 v93, v71, v70, 16
    ds_write_b128 v6, v[74:77] offset:8320
    ds_write_b128 v6, v[76:79] offset:24960
    ds_write_b128 v6, v[80:83] offset:4160
    ds_write_b128 v6, v[82:85] offset:20800
    ds_write_b128 v6, v[88:91] offset:12480
    ds_write_b128 v6, v[90:93] offset:29120
    s_waitcnt vmcnt(0)
    ds_write_b128 v24, v[108:111] offset:35760
    s_lshr_b32 s30, s36, 16
    s_and_b32 s31, s36, 0xffff
    s_cmp_eq_u32 s24, 0
    s_cselect_b32 s36, s31, s30
    v_mov_b32 v60, s36
    s_cselect_b64 vcc, -1, 0
    v_cndmask_b32 v61, v105, v104, vcc
    v_and_b32 v3, 31, v1
    v_lshrrev_b32 v4, 5, v1
    v_and_b32 v5, 7, v3
    v_sub_u32 v5, 7, v5
    v_mul_u32_u24 v5, 4160, v5
    v_lshrrev_b32 v6, 3, v3
    v_sub_u32 v6, v4, v6
    v_lshlrev_b32 v6, 4, v6
    v_add_u32 v5, v5, v6
    s_lshl_b32 s28, s26, 9
    s_sub_u32 s28, 1584, s28
    s_add_u32 s28, s28, s27
    v_add_u32 v5, s28, v5
    v_mul_u32_u24 v6, 80, v3
    v_lshlrev_b32 v7, 4, v4
    v_add_u32 v6, v6, v7
    s_mul_i32 s28, s26, 640
    s_sub_u32 s28, 35200, s28
    s_add_u32 s28, s28, s27
    v_add_u32 v6, s28, v6
    v_mov_b32 v24, 0
    v_mov_b32 v25, 0
    v_mov_b32 v26, 0
    v_mov_b32 v27, 0
    v_mov_b32 v28, 0
    v_mov_b32 v29, 0
    v_mov_b32 v30, 0
    v_mov_b32 v31, 0
    v_mov_b32 v32, 0
    v_mov_b32 v33, 0
    v_mov_b32 v34, 0
    v_mov_b32 v35, 0
    v_mov_b32 v36, 0
    v_mov_b32 v37, 0
    v_mov_b32 v38, 0
    v_mov_b32 v39, 0
    v_mov_b32 v40, 0
    v_mov_b32 v41, 0
    v_mov_b32 v42, 0
    v_mov_b32 v43, 0
    v_mov_b32 v44, 0
    v_mov_b32 v45, 0
    v_mov_b32 v46, 0
    v_mov_b32 v47, 0
    v_mov_b32 v48, 0
    v_mov_b32 v49, 0
    v_mov_b32 v50, 0
    v_mov_b32 v51, 0
    v_mov_b32 v52, 0
    v_mov_b32 v53, 0
    v_mov_b32 v54, 0
    v_mov_b32 v55, 0
    s_waitcnt lgkmcnt(0)
    s_barrier
    ds_read_b128 v[64:67], v5 offset:2496
    ds_read_b128 v[68:71], v5 offset:448
    ds_read_b128 v[72:75], v6 offset:560
    ds_read_b128 v[76:79], v6 offset:3120
    ds_read_b128 v[80:83], v5 offset:2528
    ds_read_b128 v[84:87], v5 offset:480
    ds_read_b128 v[88:91], v6 offset:592
    ds_read_b128 v[92:95], v6 offset:3152
    ds_read_b128 v[96:99], v5 offset:2432
    ds_read_b128 v[100:103], v5 offset:384
    ds_read_b128 v[104:107], v6 offset:480
    ds_read_b128 v[108:111], v6 offset:3040
    s_waitcnt lgkmcnt(8)
    v_mfma_f32_32x32x16_f16 v[24:39], v[64:67], v[72:75], v[24:39]
    v_mfma_f32_32x32x16_f16 v[40:55], v[64:67], v[76:79], v[40:55]
    v_mfma_f32_32x32x16_f16 v[40:55], v[68:71], v[72:75], v[40:55]
    ds_read_b128 v[64:67], v5 offset:2464
    ds_read_b128 v[68:71], v5 offset:416
    ds_read_b128 v[72:75], v6 offset:512
    ds_read_b128 v[76:79], v6 offset:3072
    s_waitcnt lgkmcnt(8)
    v_mfma_f32_32x32x16_f16 v[24:39], v[80:83], v[88:91], v[24:39]
    v_mfma_f32_32x32x16_f16 v[40:55], v[80:83], v[92:95], v[40:55]
    v_mfma_f32_32x32x16_f16 v[40:55], v[84:87], v[88:91], v[40:55]
    ds_read_b128 v[80:83], v5 offset:2368
    ds_read_b128 v[84:87], v5 offset:320
    ds_read_b128 v[88:91], v6 offset:400
    ds_read_b128 v[92:95], v6 offset:2960
    s_waitcnt lgkmcnt(8)
    v_mfma_f32_32x32x16_f16 v[24:39], v[96:99], v[104:107], v[24:39]
    v_mfma_f32_32x32x16_f16 v[40:55], v[96:99], v[108:111], v[40:55]
    v_mfma_f32_32x32x16_f16 v[40:55], v[100:103], v[104:107], v[40:55]
    ds_read_b128 v[96:99], v5 offset:2400
    ds_read_b128 v[100:103], v5 offset:352
    ds_read_b128 v[104:107], v6 offset:432
    ds_read_b128 v[108:111], v6 offset:2992
    s_waitcnt lgkmcnt(8)
    v_mfma_f32_32x32x16_f16 v[24:39], v[64:67], v[72:75], v[24:39]
    v_mfma_f32_32x32x16_f16 v[40:55], v[64:67], v[76:79], v[40:55]
    v_mfma_f32_32x32x16_f16 v[40:55], v[68:71], v[72:75], v[40:55]
    ds_read_b128 v[64:67], v5 offset:2304
    ds_read_b128 v[68:71], v5 offset:256
    ds_read_b128 v[72:75], v6 offset:320
    ds_read_b128 v[76:79], v6 offset:2880
    s_waitcnt lgkmcnt(8)
    v_mfma_f32_32x32x16_f16 v[24:39], v[80:83], v[88:91], v[24:39]
    v_mfma_f32_32x32x16_f16 v[40:55], v[80:83], v[92:95], v[40:55]
    v_mfma_f32_32x32x16_f16 v[40:55], v[84:87], v[88:91], v[40:55]
    ds_read_b128 v[80:83], v5 offset:2336
    ds_read_b128 v[84:87], v5 offset:288
    ds_read_b128 v[88:91], v6 offset:352
    ds_read_b128 v[92:95], v6 offset:2912
    s_waitcnt lgkmcnt(8)
    v_mfma_f32_32x32x16_f16 v[24:39], v[96:99], v[104:107], v[24:39]
    v_mfma_f32_32x32x16_f16 v[40:55], v[96:99], v[108:111], v[40:55]
    v_mfma_f32_32x32x16_f16 v[40:55], v[100:103], v[104:107], v[40:55]
    ds_read_b128 v[96:99], v5 offset:2240
    ds_read_b128 v[100:103], v5 offset:192
    ds_read_b128 v[104:107], v6 offset:240
    ds_read_b128 v[108:111], v6 offset:2800
    s_waitcnt lgkmcnt(8)
    v_mfma_f32_32x32x16_f16 v[24:39], v[64:67], v[72:75], v[24:39]
    v_mfma_f32_32x32x16_f16 v[40:55], v[64:67], v[76:79], v[40:55]
    v_mfma_f32_32x32x16_f16 v[40:55], v[68:71], v[72:75], v[40:55]
    ds_read_b128 v[64:67], v5 offset:2272
    ds_read_b128 v[68:71], v5 offset:224
    ds_read_b128 v[72:75], v6 offset:272
    ds_read_b128 v[76:79], v6 offset:2832
    s_waitcnt lgkmcnt(8)
    v_mfma_f32_32x32x16_f16 v[24:39], v[80:83], v[88:91], v[24:39]
    v_mfma_f32_32x32x16_f16 v[40:55], v[80:83], v[92:95], v[40:55]
    v_mfma_f32_32x32x16_f16 v[40:55], v[84:87], v[88:91], v[40:55]
    ds_read_b128 v[80:83], v5 offset:2176
    ds_read_b128 v[84:87], v5 offset:128
    ds_read_b128 v[88:91], v6 offset:160
    ds_read_b128 v[92:95], v6 offset:2720
    s_waitcnt lgkmcnt(8)
    v_mfma_f32_32x32x16_f16 v[24:39], v[96:99], v[104:107], v[24:39]
    v_mfma_f32_32x32x16_f16 v[40:55], v[96:99], v[108:111], v[40:55]
    v_mfma_f32_32x32x16_f16 v[40:55], v[100:103], v[104:107], v[40:55]
    ds_read_b128 v[96:99], v5 offset:2208
    ds_read_b128 v[100:103], v5 offset:160
    ds_read_b128 v[104:107], v6 offset:192
    ds_read_b128 v[108:111], v6 offset:2752
    s_waitcnt lgkmcnt(8)
    v_mfma_f32_32x32x16_f16 v[24:39], v[64:67], v[72:75], v[24:39]
    v_mfma_f32_32x32x16_f16 v[40:55], v[64:67], v[76:79], v[40:55]
    v_mfma_f32_32x32x16_f16 v[40:55], v[68:71], v[72:75], v[40:55]
    ds_read_b128 v[64:67], v5 offset:2112
    ds_read_b128 v[68:71], v5 offset:64
    ds_read_b128 v[72:75], v6 offset:80
    ds_read_b128 v[76:79], v6 offset:2640
    s_waitcnt lgkmcnt(8)
    v_mfma_f32_32x32x16_f16 v[24:39], v[80:83], v[88:91], v[24:39]
    v_mfma_f32_32x32x16_f16 v[40:55], v[80:83], v[92:95], v[40:55]
    v_mfma_f32_32x32x16_f16 v[40:55], v[84:87], v[88:91], v[40:55]
    ds_read_b128 v[80:83], v5 offset:2144
    ds_read_b128 v[84:87], v5 offset:96
    ds_read_b128 v[88:91], v6 offset:112
    ds_read_b128 v[92:95], v6 offset:2672
    s_waitcnt lgkmcnt(8)
    v_mfma_f32_32x32x16_f16 v[24:39], v[96:99], v[104:107], v[24:39]
    v_mfma_f32_32x32x16_f16 v[40:55], v[96:99], v[108:111], v[40:55]
    v_mfma_f32_32x32x16_f16 v[40:55], v[100:103], v[104:107], v[40:55]
    ds_read_b128 v[96:99], v5 offset:2048
    ds_read_b128 v[100:103], v5 offset:0
    ds_read_b128 v[104:107], v6 offset:0
    ds_read_b128 v[108:111], v6 offset:2560
    s_waitcnt lgkmcnt(8)
    v_mfma_f32_32x32x16_f16 v[24:39], v[64:67], v[72:75], v[24:39]
    v_mfma_f32_32x32x16_f16 v[40:55], v[64:67], v[76:79], v[40:55]
    v_mfma_f32_32x32x16_f16 v[40:55], v[68:71], v[72:75], v[40:55]
    ds_read_b128 v[64:67], v5 offset:2080
    ds_read_b128 v[68:71], v5 offset:32
    ds_read_b128 v[72:75], v6 offset:32
    ds_read_b128 v[76:79], v6 offset:2592
    s_waitcnt lgkmcnt(8)
    v_mfma_f32_32x32x16_f16 v[24:39], v[80:83], v[88:91], v[24:39]
    v_mfma_f32_32x32x16_f16 v[40:55], v[80:83], v[92:95], v[40:55]
    v_mfma_f32_32x32x16_f16 v[40:55], v[84:87], v[88:91], v[40:55]
    s_waitcnt lgkmcnt(4)
    v_mfma_f32_32x32x16_f16 v[24:39], v[96:99], v[104:107], v[24:39]
    v_mfma_f32_32x32x16_f16 v[40:55], v[96:99], v[108:111], v[40:55]
    v_mfma_f32_32x32x16_f16 v[40:55], v[100:103], v[104:107], v[40:55]
    s_waitcnt lgkmcnt(0)
    v_mfma_f32_32x32x16_f16 v[24:39], v[64:67], v[72:75], v[24:39]
    v_mfma_f32_32x32x16_f16 v[40:55], v[64:67], v[76:79], v[40:55]
    v_mfma_f32_32x32x16_f16 v[40:55], v[68:71], v[72:75], v[40:55]
    s_barrier
    v_lshlrev_b32 v7, 4, v1
    s_lshl_b32 s28, s26, 13
    s_add_u32 s28, s28, s27
    v_add_u32 v8, s28, v7
    v_lshrrev_b32 v11, 2, v1
    v_and_b32 v17, 3, v1
    s_and_b32 s29, s26, 1
    s_lshl_b32 s29, s29, 4
    v_add_u32 v11, s29, v11
    v_lshlrev_b32 v9, 10, v17
    v_lshlrev_b32 v10, 4, v11
    v_add_u32 v9, v9, v10
    s_lshr_b32 s28, s26, 1
    s_lshl_b32 s29, s28, 12
    s_add_u32 s29, s29, s27
    v_add_u32 v9, s29, v9
    v_mul_u32_u24 v10, 80, v11
    v_lshlrev_b32 v17, 4, v17
    v_add_u32 v10, v10, v17
    s_mul_i32 s28, s28, 2560
    s_add_u32 s28, s28, 35760
    s_add_u32 s28, s28, s27
    v_add_u32 v10, s28, v10
    s_nop 4
    ds_write_b128 v8, v[24:27] offset:0
    ds_write_b128 v8, v[28:31] offset:1024
    ds_write_b128 v8, v[32:35] offset:2048
    ds_write_b128 v8, v[36:39] offset:3072
    ds_write_b128 v8, v[40:43] offset:4096
    ds_write_b128 v8, v[44:47] offset:5120
    ds_write_b128 v8, v[48:51] offset:6144
    ds_write_b128 v8, v[52:55] offset:7168
    ds_read_b128 v[12:15], v10
    s_waitcnt lgkmcnt(0)
    s_barrier
    ds_read_b128 v[64:67], v9 offset:0
    ds_read_b128 v[68:71], v9 offset:512
    ds_read_b128 v[72:75], v9 offset:8192
    ds_read_b128 v[76:79], v9 offset:8704
    ds_read_b128 v[80:83], v9 offset:16384
    ds_read_b128 v[84:87], v9 offset:16896
    ds_read_b128 v[88:91], v9 offset:24576
    ds_read_b128 v[92:95], v9 offset:25088
    v_lshlrev_b32 v60, 16, v60
    v_lshlrev_b32 v16, 4, v1
    s_lshl_b32 s28, s26, 10
    s_lshl_b32 s29, s25, 12
    s_add_u32 s28, s28, s29
    v_cvt_f32_f16 v24, v12
    v_cvt_f32_f16_sdwa v25, v12 dst_sel:DWORD dst_unused:UNUSED_PAD src0_sel:WORD_1
    v_cvt_f32_f16 v26, v13
    v_cvt_f32_f16_sdwa v27, v13 dst_sel:DWORD dst_unused:UNUSED_PAD src0_sel:WORD_1
    v_cvt_f32_f16 v28, v14
    v_cvt_f32_f16_sdwa v29, v14 dst_sel:DWORD dst_unused:UNUSED_PAD src0_sel:WORD_1
    v_cvt_f32_f16 v30, v15
    v_cvt_f32_f16_sdwa v31, v15 dst_sel:DWORD dst_unused:UNUSED_PAD src0_sel:WORD_1
    v_mul_f32 v24, v24, v60
    v_mul_f32 v25, v25, v60
    v_mul_f32 v26, v26, v60
    v_mul_f32 v27, v27, v60
    v_mul_f32 v28, v28, v60
    v_mul_f32 v29, v29, v60
    v_mul_f32 v30, v30, v60
    v_mul_f32 v31, v31, v60
    v_cvt_pk_bf16_f32 v32, v24, v25
    v_cvt_pk_bf16_f32 v33, v26, v27
    v_cvt_pk_bf16_f32 v34, v28, v29
    v_cvt_pk_bf16_f32 v35, v30, v31
    v_lshlrev_b32 v24, 16, v32
    v_and_b32 v25, 0xffff0000, v32
    v_lshlrev_b32 v26, 16, v33
    v_and_b32 v27, 0xffff0000, v33
    v_lshlrev_b32 v28, 16, v34
    v_and_b32 v29, 0xffff0000, v34
    v_lshlrev_b32 v30, 16, v35
    v_and_b32 v31, 0xffff0000, v35
    s_waitcnt lgkmcnt(0)
    v_add_f32 v64, v64, v72
    v_add_f32 v80, v80, v88
    v_add_f32 v65, v65, v73
    v_add_f32 v81, v81, v89
    v_add_f32 v66, v66, v74
    v_add_f32 v82, v82, v90
    v_add_f32 v67, v67, v75
    v_add_f32 v83, v83, v91
    v_add_f32 v68, v68, v76
    v_add_f32 v84, v84, v92
    v_add_f32 v69, v69, v77
    v_add_f32 v85, v85, v93
    v_add_f32 v70, v70, v78
    v_add_f32 v86, v86, v94
    v_add_f32 v71, v71, v79
    v_add_f32 v87, v87, v95
    v_add_f32 v64, v64, v80
    v_add_f32 v65, v65, v81
    v_add_f32 v66, v66, v82
    v_add_f32 v67, v67, v83
    v_add_f32 v68, v68, v84
    v_add_f32 v69, v69, v85
    v_add_f32 v70, v70, v86
    v_add_f32 v71, v71, v87
    v_mul_f32 v64, v64, v61
    v_mul_f32 v65, v65, v61
    v_mul_f32 v66, v66, v61
    v_mul_f32 v67, v67, v61
    v_mul_f32 v68, v68, v61
    v_mul_f32 v69, v69, v61
    v_mul_f32 v70, v70, v61
    v_mul_f32 v71, v71, v61
    v_cvt_pk_bf16_f32 v32, v64, v65
    v_cvt_pk_bf16_f32 v33, v66, v67
    v_cvt_pk_bf16_f32 v34, v68, v69
    v_cvt_pk_bf16_f32 v35, v70, v71
    v_lshlrev_b32 v64, 16, v32
    v_and_b32 v65, 0xffff0000, v32
    v_lshlrev_b32 v66, 16, v33
    v_and_b32 v67, 0xffff0000, v33
    v_lshlrev_b32 v68, 16, v34
    v_and_b32 v69, 0xffff0000, v34
    v_lshlrev_b32 v70, 16, v35
    v_and_b32 v71, 0xffff0000, v35
    v_add_f32 v64, v64, v24
    v_add_f32 v65, v65, v25
    v_add_f32 v66, v66, v26
    v_add_f32 v67, v67, v27
    v_add_f32 v68, v68, v28
    v_add_f32 v69, v69, v29
    v_add_f32 v70, v70, v30
    v_add_f32 v71, v71, v31
    v_cvt_pk_bf16_f32 v32, v64, v65
    v_cvt_pk_bf16_f32 v33, v66, v67
    v_cvt_pk_bf16_f32 v34, v68, v69
    v_cvt_pk_bf16_f32 v35, v70, v71
    buffer_store_dwordx4 v[32:35], v16, s[16:19], s28 offen sc1
    s_waitcnt vmcnt(0)
    s_barrier
    s_cmp_lg_u32 s3, 0
    s_cbranch_scc1 CV_NOSIG
    s_lshr_b32 s28, s2, 5
    s_and_b32 s29, s2, 31
    s_lshl_b32 s29, s29, 2
    s_add_u32 s29, s29, 64
    v_mov_b32 v13, s28
    v_and_b32 v12, 3, v1
    v_lshlrev_b32 v12, 3, v12
    v_add_u32 v12, v12, v13
    v_lshlrev_b32 v12, 3, v12
    v_lshrrev_b32 v14, 2, v1
    v_add_u32 v12, v12, v14
    v_lshlrev_b32 v12, 8, v12
    v_add_u32 v12, 6815744, v12
    v_add_u32 v12, s29, v12
    v_mov_b32 v13, 0x01010101
    v_cmp_gt_u32 vcc, 32, v1
    s_and_saveexec_b64 s[30:31], vcc
    global_store_dword v12, v13, s[22:23] sc1
    s_mov_b64 exec, s[30:31]
CV_NOSIG:
    s_endpgm
M_G:
    s_setprio 2
    s_sub_u32 s2, s2, 256
    s_load_dwordx2 s[56:57], s[0:1], 0
    s_load_dwordx2 s[58:59], s[0:1], 104
    s_mov_b32 s61, 0
    s_cmp_ge_u32 s2, 224
    s_cbranch_scc1 M_G2PRE
    s_load_dwordx2 s[4:5], s[0:1], 88
    s_load_dwordx2 s[6:7], s[0:1], 0
    s_load_dwordx2 s[36:37], s[0:1], 80
    s_lshr_b32 s25, s2, 3
    s_mul_i32 s26, s25, 37
    s_lshr_b32 s26, s26, 8
    s_mul_i32 s27, s26, 7
    s_sub_u32 s25, s25, s27
    s_and_b32 s24, s2, 6
    s_lshl_b32 s24, s24, 1
    s_add_u32 s24, s24, s26
    s_and_b32 s27, s2, 1
    s_mul_i32 s27, s27, 7
    s_add_u32 s25, s25, s27
    v_lshrrev_b32 v3, 4, v1
    v_and_b32 v4, 15, v1
    v_lshlrev_b32 v5, 2, v3
    v_xor_b32 v4, v4, v5
    v_lshlrev_b32 v4, 4, v4
    s_lshl_b32 s26, s3, 2
    v_add_u32 v3, s26, v3
    v_mul_u32_u24 v3, 3584, v3
    v_add_u32 v3, v3, v4
    s_lshl_b32 s26, s25, 8
    v_add_u32 v8, s26, v3
    v_lshrrev_b32 v3, 2, v1
    v_and_b32 v4, 3, v1
    v_lshrrev_b32 v5, 2, v3
    v_xor_b32 v4, v4, v5
    v_lshlrev_b32 v4, 4, v4
    s_lshl_b32 s26, s3, 4
    v_add_u32 v3, s26, v3
    v_lshlrev_b32 v3, 10, v3
    v_add_u32 v3, v3, v4
    s_lshl_b32 s26, s24, 17
    v_add_u32 v9, s26, v3
    s_lshl_b32 s28, s3, 10
    s_waitcnt lgkmcnt(0)
    s_mov_b32 s8, s36
    s_mov_b32 s9, s37
    s_mov_b32 s10, 1835008
    s_mov_b32 s11, 0x00020000
    s_mov_b32 s12, s6
    s_mov_b32 s13, s7
    s_mov_b32 s14, 2097152
    s_mov_b32 s15, 0x00020000
    s_add_u32 s16, s22, 12582912
    s_addc_u32 s17, s23, 0
    s_mov_b32 s18, 7340032
    s_mov_b32 s19, 0x00020000
    s_mov_b32 s30, 0
    s_mov_b32 s31, 0
    s_add_u32 m0, s28, 0
    s_nop 0
    buffer_load_dwordx4 v8, s[8:11], s30 offen lds
    s_add_u32 m0, s28, 8192
    s_nop 0
    buffer_load_dwordx4 v9, s[12:15], s31 offen lds
    s_mov_b32 s30, 114688
    s_mov_b32 s31, 64
    s_add_u32 m0, s28, 16384
    s_nop 0
    buffer_load_dwordx4 v8, s[8:11], s30 offen lds
    s_add_u32 m0, s28, 24576
    s_nop 0
    buffer_load_dwordx4 v9, s[12:15], s31 offen lds
    s_mov_b32 s30, 229376
    s_mov_b32 s31, 128
    s_add_u32 m0, s28, 32768
    s_nop 0
    buffer_load_dwordx4 v8, s[8:11], s30 offen lds
    s_add_u32 m0, s28, 40960
    s_nop 0
    buffer_load_dwordx4 v9, s[12:15], s31 offen lds
    s_mov_b32 s30, 344064
    s_mov_b32 s31, 192
    s_add_u32 m0, s28, 49152
    s_nop 0
    buffer_load_dwordx4 v8, s[8:11], s30 offen lds
    s_add_u32 m0, s28, 57344
    s_nop 0
    buffer_load_dwordx4 v9, s[12:15], s31 offen lds
    s_mov_b32 s30, 458752
    s_mov_b32 s31, 256
    s_add_u32 m0, s28, 65536
    s_nop 0
    buffer_load_dwordx4 v8, s[8:11], s30 offen lds
    s_add_u32 m0, s28, 73728
    s_nop 0
    buffer_load_dwordx4 v9, s[12:15], s31 offen lds
    v_lshrrev_b32 v3, 4, v1
    v_and_b32 v4, 15, v1
    v_lshrrev_b32 v5, 2, v4
    v_lshrrev_b32 v6, 1, v3
    v_lshlrev_b32 v6, 3, v6
    v_add_u32 v6, v6, v5
    v_lshlrev_b32 v6, 8, v6
    v_and_b32 v7, 1, v4
    v_lshlrev_b32 v7, 3, v7
    v_add_u32 v6, v6, v7
    v_and_b32 v7, 1, v3
    v_lshlrev_b32 v7, 1, v7
    v_bfe_u32 v10, v4, 1, 1
    v_add_u32 v7, v7, v10
    s_and_b32 s29, s3, 1
    s_lshl_b32 s29, s29, 3
    v_add_u32 v7, s29, v7
    v_lshlrev_b32 v5, 2, v5
    v_xor_b32 v10, v7, v5
    v_lshlrev_b32 v10, 4, v10
    v_add_u32 v16, v6, v10
    v_add_u32 v7, 4, v7
    v_xor_b32 v10, v7, v5
    v_lshlrev_b32 v10, 4, v10
    v_add_u32 v17, v6, v10
    v_and_b32 v3, 31, v1
    v_lshrrev_b32 v4, 5, v1
    v_lshrrev_b32 v5, 2, v3
    v_and_b32 v5, 3, v5
    v_lshlrev_b32 v6, 6, v3
    s_lshr_b32 s30, s3, 1
    s_lshl_b32 s30, s30, 11
    s_add_u32 s30, s30, 8192
    v_add_u32 v6, s30, v6
    v_xor_b32 v7, v4, v5
    v_lshlrev_b32 v7, 4, v7
    v_add_u32 v18, v6, v7
    v_add_u32 v7, 2, v4
    v_xor_b32 v7, v7, v5
    v_lshlrev_b32 v7, 4, v7
    v_add_u32 v19, v6, v7
    v_mov_b32 v64, 0
    v_mov_b32 v65, 0
    v_mov_b32 v66, 0
    v_mov_b32 v67, 0
    v_mov_b32 v68, 0
    v_mov_b32 v69, 0
    v_mov_b32 v70, 0
    v_mov_b32 v71, 0
    v_mov_b32 v72, 0
    v_mov_b32 v73, 0
    v_mov_b32 v74, 0
    v_mov_b32 v75, 0
    v_mov_b32 v76, 0
    v_mov_b32 v77, 0
    v_mov_b32 v78, 0
    v_mov_b32 v79, 0
    v_mov_b32 v80, 0
    v_mov_b32 v81, 0
    v_mov_b32 v82, 0
    v_mov_b32 v83, 0
    v_mov_b32 v84, 0
    v_mov_b32 v85, 0
    v_mov_b32 v86, 0
    v_mov_b32 v87, 0
    v_mov_b32 v88, 0
    v_mov_b32 v89, 0
    v_mov_b32 v90, 0
    v_mov_b32 v91, 0
    v_mov_b32 v92, 0
    v_mov_b32 v93, 0
    v_mov_b32 v94, 0
    v_mov_b32 v95, 0
    v_add_u32 v11, 0x10000, v16
    v_add_u32 v12, 0x10000, v17
    v_add_u32 v13, 0x10000, v18
    v_add_u32 v14, 0x10000, v19
    v_mov_b32 v58, 0
    v_mov_b32 v59, 0
    v_mov_b32 v61, 0
    v_mov_b32 v62, 0
    s_mov_b32 s33, 0x3f803f80
    s_lshr_b32 s34, s3, 1
    s_add_u32 s44, s22, 0
    s_addc_u32 s45, s23, 0
    s_lshl_b32 s26, s24, 7
    s_lshl_b32 s27, s34, 5
    s_add_u32 s26, s26, s27
    v_add_u32 v22, s26, v3
    v_lshlrev_b32 v22, 3, v22
    s_and_b32 s40, s24, 7
    s_lshl_b32 s40, s40, 5
    s_lshr_b32 s41, s24, 3
    s_mul_i32 s41, s41, 118784
    s_add_u32 s40, s40, s41
    s_add_u32 s40, s40, 6553600
    s_waitcnt vmcnt(8)
    s_barrier
    ds_read_b64_tr_b16 v[96:97], v16 offset:0
    ds_read_b64_tr_b16 v[98:99], v16 offset:1024
    ds_read_b64_tr_b16 v[100:101], v17 offset:0
    ds_read_b64_tr_b16 v[102:103], v17 offset:1024
    ds_read_b128 v[104:107], v18 offset:0
    ds_read_b64_tr_b16 v[108:109], v16 offset:4096
    ds_read_b64_tr_b16 v[110:111], v16 offset:5120
    ds_read_b64_tr_b16 v[112:113], v17 offset:4096
    ds_read_b64_tr_b16 v[114:115], v17 offset:5120
    ds_read_b128 v[116:119], v19 offset:0
    s_waitcnt vmcnt(6) lgkmcnt(0)
    s_barrier
    v_mfma_f32_32x32x16_bf16 v[64:79], v[96:99], v[104:107], v[64:79]
    ds_read_b64_tr_b16 v[26:27], v16 offset:16384
    ds_read_b64_tr_b16 v[28:29], v16 offset:17408
    ds_read_b64_tr_b16 v[30:31], v17 offset:16384
    ds_read_b64_tr_b16 v[32:33], v17 offset:17408
    ds_read_b128 v[34:37], v18 offset:16384
    v_mfma_f32_32x32x16_bf16 v[80:95], v[100:103], v[104:107], v[80:95]
    ds_read_b64_tr_b16 v[38:39], v16 offset:20480
    ds_read_b64_tr_b16 v[40:41], v16 offset:21504
    ds_read_b64_tr_b16 v[42:43], v17 offset:20480
    ds_read_b64_tr_b16 v[44:45], v17 offset:21504
    ds_read_b128 v[46:49], v19 offset:16384
    v_mfma_f32_32x32x16_bf16 v[64:79], v[108:111], v[116:119], v[64:79]
    s_mov_b32 s30, 573440
    s_mov_b32 s31, 320
    s_add_u32 m0, s28, 0
    s_nop 0
    buffer_load_dwordx4 v8, s[8:11], s30 offen lds
    s_add_u32 m0, s28, 8192
    s_nop 0
    buffer_load_dwordx4 v9, s[12:15], s31 offen lds
    v_mfma_f32_32x32x16_bf16 v[80:95], v[112:115], v[116:119], v[80:95]
    s_waitcnt vmcnt(6) lgkmcnt(0)
    s_barrier
    v_mfma_f32_32x32x16_bf16 v[64:79], v[26:29], v[34:37], v[64:79]
    ds_read_b64_tr_b16 v[96:97], v16 offset:32768
    ds_read_b64_tr_b16 v[98:99], v16 offset:33792
    ds_read_b64_tr_b16 v[100:101], v17 offset:32768
    ds_read_b64_tr_b16 v[102:103], v17 offset:33792
    ds_read_b128 v[104:107], v18 offset:32768
    v_mfma_f32_32x32x16_bf16 v[80:95], v[30:33], v[34:37], v[80:95]
    ds_read_b64_tr_b16 v[108:109], v16 offset:36864
    ds_read_b64_tr_b16 v[110:111], v16 offset:37888
    ds_read_b64_tr_b16 v[112:113], v17 offset:36864
    ds_read_b64_tr_b16 v[114:115], v17 offset:37888
    ds_read_b128 v[116:119], v19 offset:32768
    v_mfma_f32_32x32x16_bf16 v[64:79], v[38:41], v[46:49], v[64:79]
    s_mov_b32 s30, 688128
    s_mov_b32 s31, 384
    s_add_u32 m0, s28, 16384
    s_nop 0
    buffer_load_dwordx4 v8, s[8:11], s30 offen lds
    s_add_u32 m0, s28, 24576
    s_nop 0
    buffer_load_dwordx4 v9, s[12:15], s31 offen lds
    v_mfma_f32_32x32x16_bf16 v[80:95], v[42:45], v[46:49], v[80:95]
    s_waitcnt vmcnt(6) lgkmcnt(0)
    s_barrier
    v_mfma_f32_32x32x16_bf16 v[64:79], v[96:99], v[104:107], v[64:79]
    ds_read_b64_tr_b16 v[26:27], v16 offset:49152
    ds_read_b64_tr_b16 v[28:29], v16 offset:50176
    ds_read_b64_tr_b16 v[30:31], v17 offset:49152
    ds_read_b64_tr_b16 v[32:33], v17 offset:50176
    ds_read_b128 v[34:37], v18 offset:49152
    v_mfma_f32_32x32x16_bf16 v[80:95], v[100:103], v[104:107], v[80:95]
    ds_read_b64_tr_b16 v[38:39], v16 offset:53248
    ds_read_b64_tr_b16 v[40:41], v16 offset:54272
    ds_read_b64_tr_b16 v[42:43], v17 offset:53248
    ds_read_b64_tr_b16 v[44:45], v17 offset:54272
    ds_read_b128 v[46:49], v19 offset:49152
    v_mfma_f32_32x32x16_bf16 v[64:79], v[108:111], v[116:119], v[64:79]
    s_mov_b32 s30, 802816
    s_mov_b32 s31, 448
    s_add_u32 m0, s28, 32768
    s_nop 0
    buffer_load_dwordx4 v8, s[8:11], s30 offen lds
    s_add_u32 m0, s28, 40960
    s_nop 0
    buffer_load_dwordx4 v9, s[12:15], s31 offen lds
    v_mfma_f32_32x32x16_bf16 v[80:95], v[112:115], v[116:119], v[80:95]
    s_waitcnt vmcnt(6) lgkmcnt(0)
    s_barrier
    v_mfma_f32_32x32x16_bf16 v[64:79], v[26:29], v[34:37], v[64:79]
    ds_read_b64_tr_b16 v[96:97], v11 offset:0
    ds_read_b64_tr_b16 v[98:99], v11 offset:1024
    ds_read_b64_tr_b16 v[100:101], v12 offset:0
    ds_read_b64_tr_b16 v[102:103], v12 offset:1024
    ds_read_b128 v[104:107], v13 offset:0
    v_mfma_f32_32x32x16_bf16 v[80:95], v[30:33], v[34:37], v[80:95]
    ds_read_b64_tr_b16 v[108:109], v11 offset:4096
    ds_read_b64_tr_b16 v[110:111], v11 offset:5120
    ds_read_b64_tr_b16 v[112:113], v12 offset:4096
    ds_read_b64_tr_b16 v[114:115], v12 offset:5120
    ds_read_b128 v[116:119], v14 offset:0
    v_mfma_f32_32x32x16_bf16 v[64:79], v[38:41], v[46:49], v[64:79]
    s_mov_b32 s30, 917504
    s_mov_b32 s31, 512
    s_add_u32 m0, s28, 49152
    s_nop 0
    buffer_load_dwordx4 v8, s[8:11], s30 offen lds
    s_add_u32 m0, s28, 57344
    s_nop 0
    buffer_load_dwordx4 v9, s[12:15], s31 offen lds
    v_mfma_f32_32x32x16_bf16 v[80:95], v[42:45], v[46:49], v[80:95]
    s_waitcnt vmcnt(6) lgkmcnt(0)
    s_barrier
    v_mfma_f32_32x32x16_bf16 v[64:79], v[96:99], v[104:107], v[64:79]
    ds_read_b64_tr_b16 v[26:27], v16 offset:0
    ds_read_b64_tr_b16 v[28:29], v16 offset:1024
    ds_read_b64_tr_b16 v[30:31], v17 offset:0
    ds_read_b64_tr_b16 v[32:33], v17 offset:1024
    ds_read_b128 v[34:37], v18 offset:0
    v_mfma_f32_32x32x16_bf16 v[80:95], v[100:103], v[104:107], v[80:95]
    ds_read_b64_tr_b16 v[38:39], v16 offset:4096
    ds_read_b64_tr_b16 v[40:41], v16 offset:5120
    ds_read_b64_tr_b16 v[42:43], v17 offset:4096
    ds_read_b64_tr_b16 v[44:45], v17 offset:5120
    ds_read_b128 v[46:49], v19 offset:0
    v_mfma_f32_32x32x16_bf16 v[64:79], v[108:111], v[116:119], v[64:79]
    s_mov_b32 s30, 1032192
    s_mov_b32 s31, 576
    s_add_u32 m0, s28, 65536
    s_nop 0
    buffer_load_dwordx4 v8, s[8:11], s30 offen lds
    s_add_u32 m0, s28, 73728
    s_nop 0
    buffer_load_dwordx4 v9, s[12:15], s31 offen lds
    v_mfma_f32_32x32x16_bf16 v[80:95], v[112:115], v[116:119], v[80:95]
    s_waitcnt vmcnt(6) lgkmcnt(0)
    s_barrier
    v_mfma_f32_32x32x16_bf16 v[64:79], v[26:29], v[34:37], v[64:79]
    ds_read_b64_tr_b16 v[96:97], v16 offset:16384
    ds_read_b64_tr_b16 v[98:99], v16 offset:17408
    ds_read_b64_tr_b16 v[100:101], v17 offset:16384
    ds_read_b64_tr_b16 v[102:103], v17 offset:17408
    ds_read_b128 v[104:107], v18 offset:16384
    v_mfma_f32_32x32x16_bf16 v[80:95], v[30:33], v[34:37], v[80:95]
    ds_read_b64_tr_b16 v[108:109], v16 offset:20480
    ds_read_b64_tr_b16 v[110:111], v16 offset:21504
    ds_read_b64_tr_b16 v[112:113], v17 offset:20480
    ds_read_b64_tr_b16 v[114:115], v17 offset:21504
    ds_read_b128 v[116:119], v19 offset:16384
    v_mfma_f32_32x32x16_bf16 v[64:79], v[38:41], v[46:49], v[64:79]
    s_mov_b32 s30, 1146880
    s_mov_b32 s31, 640
    s_add_u32 m0, s28, 0
    s_nop 0
    buffer_load_dwordx4 v8, s[8:11], s30 offen lds
    s_add_u32 m0, s28, 8192
    s_nop 0
    buffer_load_dwordx4 v9, s[12:15], s31 offen lds
    v_mfma_f32_32x32x16_bf16 v[80:95], v[42:45], v[46:49], v[80:95]
    s_waitcnt vmcnt(6) lgkmcnt(0)
    s_barrier
    v_mfma_f32_32x32x16_bf16 v[64:79], v[96:99], v[104:107], v[64:79]
    ds_read_b64_tr_b16 v[26:27], v16 offset:32768
    ds_read_b64_tr_b16 v[28:29], v16 offset:33792
    ds_read_b64_tr_b16 v[30:31], v17 offset:32768
    ds_read_b64_tr_b16 v[32:33], v17 offset:33792
    ds_read_b128 v[34:37], v18 offset:32768
    v_mfma_f32_32x32x16_bf16 v[80:95], v[100:103], v[104:107], v[80:95]
    ds_read_b64_tr_b16 v[38:39], v16 offset:36864
    ds_read_b64_tr_b16 v[40:41], v16 offset:37888
    ds_read_b64_tr_b16 v[42:43], v17 offset:36864
    ds_read_b64_tr_b16 v[44:45], v17 offset:37888
    ds_read_b128 v[46:49], v19 offset:32768
    v_mfma_f32_32x32x16_bf16 v[64:79], v[108:111], v[116:119], v[64:79]
    s_mov_b32 s30, 1261568
    s_mov_b32 s31, 704
    s_add_u32 m0, s28, 16384
    s_nop 0
    buffer_load_dwordx4 v8, s[8:11], s30 offen lds
    s_add_u32 m0, s28, 24576
    s_nop 0
    buffer_load_dwordx4 v9, s[12:15], s31 offen lds
    v_mfma_f32_32x32x16_bf16 v[80:95], v[112:115], v[116:119], v[80:95]
    s_waitcnt vmcnt(6) lgkmcnt(0)
    s_barrier
    v_mfma_f32_32x32x16_bf16 v[64:79], v[26:29], v[34:37], v[64:79]
    ds_read_b64_tr_b16 v[96:97], v16 offset:49152
    ds_read_b64_tr_b16 v[98:99], v16 offset:50176
    ds_read_b64_tr_b16 v[100:101], v17 offset:49152
    ds_read_b64_tr_b16 v[102:103], v17 offset:50176
    ds_read_b128 v[104:107], v18 offset:49152
    v_mfma_f32_32x32x16_bf16 v[80:95], v[30:33], v[34:37], v[80:95]
    ds_read_b64_tr_b16 v[108:109], v16 offset:53248
    ds_read_b64_tr_b16 v[110:111], v16 offset:54272
    ds_read_b64_tr_b16 v[112:113], v17 offset:53248
    ds_read_b64_tr_b16 v[114:115], v17 offset:54272
    ds_read_b128 v[116:119], v19 offset:49152
    v_mfma_f32_32x32x16_bf16 v[64:79], v[38:41], v[46:49], v[64:79]
    s_mov_b32 s30, 1376256
    s_mov_b32 s31, 768
    s_add_u32 m0, s28, 32768
    s_nop 0
    buffer_load_dwordx4 v8, s[8:11], s30 offen lds
    s_add_u32 m0, s28, 40960
    s_nop 0
    buffer_load_dwordx4 v9, s[12:15], s31 offen lds
    v_mfma_f32_32x32x16_bf16 v[80:95], v[42:45], v[46:49], v[80:95]
    s_cmp_lg_u32 s3, 0
    s_cbranch_scc1 G1_NOZL
    v_mov_b32 v23, 0
    global_load_dword v61, v23, s[20:21] sc1
G1_NOZL:
    s_waitcnt vmcnt(6) lgkmcnt(0)
    s_barrier
    v_mfma_f32_32x32x16_bf16 v[64:79], v[96:99], v[104:107], v[64:79]
    ds_read_b64_tr_b16 v[26:27], v11 offset:0
    ds_read_b64_tr_b16 v[28:29], v11 offset:1024
    ds_read_b64_tr_b16 v[30:31], v12 offset:0
    ds_read_b64_tr_b16 v[32:33], v12 offset:1024
    ds_read_b128 v[34:37], v13 offset:0
    v_mfma_f32_32x32x16_bf16 v[80:95], v[100:103], v[104:107], v[80:95]
    ds_read_b64_tr_b16 v[38:39], v11 offset:4096
    ds_read_b64_tr_b16 v[40:41], v11 offset:5120
    ds_read_b64_tr_b16 v[42:43], v12 offset:4096
    ds_read_b64_tr_b16 v[44:45], v12 offset:5120
    ds_read_b128 v[46:49], v14 offset:0
    v_mfma_f32_32x32x16_bf16 v[64:79], v[108:111], v[116:119], v[64:79]
    s_mov_b32 s30, 1490944
    s_mov_b32 s31, 832
    s_add_u32 m0, s28, 49152
    s_nop 0
    buffer_load_dwordx4 v8, s[8:11], s30 offen lds
    s_add_u32 m0, s28, 57344
    s_nop 0
    buffer_load_dwordx4 v9, s[12:15], s31 offen lds
    v_mfma_f32_32x32x16_bf16 v[80:95], v[112:115], v[116:119], v[80:95]
    s_waitcnt vmcnt(6) lgkmcnt(0)
    s_barrier
    v_mfma_f32_32x32x16_bf16 v[64:79], v[26:29], v[34:37], v[64:79]
    ds_read_b64_tr_b16 v[96:97], v16 offset:0
    ds_read_b64_tr_b16 v[98:99], v16 offset:1024
    ds_read_b64_tr_b16 v[100:101], v17 offset:0
    ds_read_b64_tr_b16 v[102:103], v17 offset:1024
    ds_read_b128 v[104:107], v18 offset:0
    v_mfma_f32_32x32x16_bf16 v[80:95], v[30:33], v[34:37], v[80:95]
    ds_read_b64_tr_b16 v[108:109], v16 offset:4096
    ds_read_b64_tr_b16 v[110:111], v16 offset:5120
    ds_read_b64_tr_b16 v[112:113], v17 offset:4096
    ds_read_b64_tr_b16 v[114:115], v17 offset:5120
    ds_read_b128 v[116:119], v19 offset:0
    v_mfma_f32_32x32x16_bf16 v[64:79], v[38:41], v[46:49], v[64:79]
    s_mov_b32 s30, 1605632
    s_mov_b32 s31, 896
    s_add_u32 m0, s28, 65536
    s_nop 0
    buffer_load_dwordx4 v8, s[8:11], s30 offen lds
    s_add_u32 m0, s28, 73728
    s_nop 0
    buffer_load_dwordx4 v9, s[12:15], s31 offen lds
    v_mfma_f32_32x32x16_bf16 v[80:95], v[42:45], v[46:49], v[80:95]
    s_waitcnt vmcnt(6) lgkmcnt(0)
    s_barrier
    v_mfma_f32_32x32x16_bf16 v[64:79], v[96:99], v[104:107], v[64:79]
    ds_read_b64_tr_b16 v[26:27], v16 offset:16384
    ds_read_b64_tr_b16 v[28:29], v16 offset:17408
    ds_read_b64_tr_b16 v[30:31], v17 offset:16384
    ds_read_b64_tr_b16 v[32:33], v17 offset:17408
    ds_read_b128 v[34:37], v18 offset:16384
    v_mfma_f32_32x32x16_bf16 v[80:95], v[100:103], v[104:107], v[80:95]
    ds_read_b64_tr_b16 v[38:39], v16 offset:20480
    ds_read_b64_tr_b16 v[40:41], v16 offset:21504
    ds_read_b64_tr_b16 v[42:43], v17 offset:20480
    ds_read_b64_tr_b16 v[44:45], v17 offset:21504
    ds_read_b128 v[46:49], v19 offset:16384
    v_mfma_f32_32x32x16_bf16 v[64:79], v[108:111], v[116:119], v[64:79]
    s_mov_b32 s30, 1720320
    s_mov_b32 s31, 960
    s_add_u32 m0, s28, 0
    s_nop 0
    buffer_load_dwordx4 v8, s[8:11], s30 offen lds
    s_add_u32 m0, s28, 8192
    s_nop 0
    buffer_load_dwordx4 v9, s[12:15], s31 offen lds
    v_mfma_f32_32x32x16_bf16 v[80:95], v[112:115], v[116:119], v[80:95]
    s_waitcnt vmcnt(6) lgkmcnt(0)
    s_barrier
    v_mfma_f32_32x32x16_bf16 v[64:79], v[26:29], v[34:37], v[64:79]
    ds_read_b64_tr_b16 v[96:97], v16 offset:32768
    ds_read_b64_tr_b16 v[98:99], v16 offset:33792
    ds_read_b64_tr_b16 v[100:101], v17 offset:32768
    ds_read_b64_tr_b16 v[102:103], v17 offset:33792
    ds_read_b128 v[104:107], v18 offset:32768
    v_mfma_f32_32x32x16_bf16 v[80:95], v[30:33], v[34:37], v[80:95]
    ds_read_b64_tr_b16 v[108:109], v16 offset:36864
    ds_read_b64_tr_b16 v[110:111], v16 offset:37888
    ds_read_b64_tr_b16 v[112:113], v17 offset:36864
    ds_read_b64_tr_b16 v[114:115], v17 offset:37888
    ds_read_b128 v[116:119], v19 offset:32768
    v_mfma_f32_32x32x16_bf16 v[64:79], v[38:41], v[46:49], v[64:79]
    v_mfma_f32_32x32x16_bf16 v[80:95], v[42:45], v[46:49], v[80:95]
    s_cmp_lg_u32 s3, 0
    s_cbranch_scc1 G1_NOPOLL
    s_waitcnt vmcnt(0)
    v_cmp_eq_u32 vcc, 0, v61
    s_nop 3
    s_cmp_eq_u64 vcc, 0
    s_cbranch_scc1 G1_ZOK
    v_mov_b32 v21, 0
WZ_g1p:
    global_load_dword v20, v21, s[20:21] sc1
    s_waitcnt vmcnt(0)
    v_cmp_eq_u32 vcc, 0, v20
    s_nop 3
    s_cmp_eq_u64 vcc, 0
    s_cbranch_scc1 WZD_g1p
    s_sleep 8
    s_branch WZ_g1p
WZD_g1p:
G1_ZOK:
    v_cmp_le_u32 vcc, 28, v1
    s_nop 1
    v_cndmask_b32 v20, 0, 1, vcc
    v_mul_u32_u24 v21, 28, v20
    v_sub_u32 v21, v1, v21
    v_lshlrev_b32 v21, 2, v21
    v_lshlrev_b32 v20, 12, v20
    v_add_u32 v20, v20, v21
    v_add_u32 v21, 6565888, v20
    v_add_u32 v20, 6557696, v20
    v_subrev_u32 v23, 56, v1
    v_lshlrev_b32 v23, 2, v23
    v_add_u32 v23, s40, v23
    s_lshl_b32 s41, s25, 2
    s_add_u32 s41, s41, 6676480
    v_mov_b32 v24, s41
    v_cmp_le_u32 vcc, 56, v1
    s_nop 1
    v_cndmask_b32 v20, v20, v23, vcc
    v_cndmask_b32 v21, v21, v24, vcc
    v_mov_b32 v23, 0
    s_mov_b32 s41, 0x01010101
POLL_g1c:
    global_load_dword v25, v20, s[22:23] sc1
    global_load_dword v60, v21, s[22:23] sc1
    s_waitcnt vmcnt(0)
    v_cmp_ne_u32 vcc, s41, v25
    v_cmp_ne_u32 s[42:43], s41, v60
    s_nop 3
    s_or_b64 vcc, vcc, s[42:43]
    s_cmp_eq_u64 vcc, 0
    s_cbranch_scc1 POLLD_g1c
    s_sleep 8
    s_branch POLL_g1c
POLLD_g1c:
G1_NOPOLL:
    s_waitcnt vmcnt(4) lgkmcnt(0)
    s_barrier
    v_mfma_f32_32x32x16_bf16 v[64:79], v[96:99], v[104:107], v[64:79]
    ds_read_b64_tr_b16 v[26:27], v16 offset:49152
    ds_read_b64_tr_b16 v[28:29], v16 offset:50176
    ds_read_b64_tr_b16 v[30:31], v17 offset:49152
    ds_read_b64_tr_b16 v[32:33], v17 offset:50176
    ds_read_b128 v[34:37], v18 offset:49152
    v_mfma_f32_32x32x16_bf16 v[80:95], v[100:103], v[104:107], v[80:95]
    ds_read_b64_tr_b16 v[38:39], v16 offset:53248
    ds_read_b64_tr_b16 v[40:41], v16 offset:54272
    ds_read_b64_tr_b16 v[42:43], v17 offset:53248
    ds_read_b64_tr_b16 v[44:45], v17 offset:54272
    ds_read_b128 v[46:49], v19 offset:49152
    v_mfma_f32_32x32x16_bf16 v[64:79], v[108:111], v[116:119], v[64:79]
    v_mfma_f32_32x32x16_bf16 v[80:95], v[112:115], v[116:119], v[80:95]
    global_load_dwordx2 v[20:21], v22, s[44:45] sc1
    s_cmp_ge_u32 s3, 2
    s_cbranch_scc1 G1_NOCSL
    s_mul_i32 s30, s3, 7168
    s_lshl_b32 s31, s25, 9
    s_add_u32 s30, s30, s31
    s_add_u32 s30, s30, 65536
    v_and_b32 v23, 31, v1
    v_lshlrev_b32 v23, 4, v23
    v_add_u32 v23, s30, v23
    s_lshl_b32 s31, s3, 10
    s_add_u32 m0, s31, 16384
    s_nop 0
    global_load_lds_dwordx4 v23, s[22:23] sc1
G1_NOCSL:
    s_waitcnt vmcnt(3) lgkmcnt(0)
    s_barrier
    v_mfma_f32_32x32x16_bf16 v[64:79], v[26:29], v[34:37], v[64:79]
    ds_read_b64_tr_b16 v[96:97], v11 offset:0
    ds_read_b64_tr_b16 v[98:99], v11 offset:1024
    ds_read_b64_tr_b16 v[100:101], v12 offset:0
    ds_read_b64_tr_b16 v[102:103], v12 offset:1024
    ds_read_b128 v[104:107], v13 offset:0
    v_mfma_f32_32x32x16_bf16 v[80:95], v[30:33], v[34:37], v[80:95]
    ds_read_b64_tr_b16 v[108:109], v11 offset:4096
    ds_read_b64_tr_b16 v[110:111], v11 offset:5120
    ds_read_b64_tr_b16 v[112:113], v12 offset:4096
    ds_read_b64_tr_b16 v[114:115], v12 offset:5120
    ds_read_b128 v[116:119], v14 offset:0
    v_mfma_f32_32x32x16_bf16 v[64:79], v[38:41], v[46:49], v[64:79]
    v_mfma_f32_32x32x16_bf16 v[80:95], v[42:45], v[46:49], v[80:95]
    s_waitcnt vmcnt(1) lgkmcnt(0)
    s_barrier
    v_mfma_f32_32x32x16_bf16 v[64:79], v[96:99], v[104:107], v[64:79]
    ds_read_b64_tr_b16 v[26:27], v16 offset:0
    ds_read_b64_tr_b16 v[28:29], v16 offset:1024
    ds_read_b64_tr_b16 v[30:31], v17 offset:0
    ds_read_b64_tr_b16 v[32:33], v17 offset:1024
    ds_read_b128 v[34:37], v18 offset:0
    v_mfma_f32_32x32x16_bf16 v[80:95], v[100:103], v[104:107], v[80:95]
    ds_read_b64_tr_b16 v[38:39], v16 offset:4096
    ds_read_b64_tr_b16 v[40:41], v16 offset:5120
    ds_read_b64_tr_b16 v[42:43], v17 offset:4096
    ds_read_b64_tr_b16 v[44:45], v17 offset:5120
    ds_read_b128 v[46:49], v19 offset:0
    v_mfma_f32_32x32x16_bf16 v[64:79], v[108:111], v[116:119], v[64:79]
    v_mfma_f32_32x32x16_bf16 v[80:95], v[112:115], v[116:119], v[80:95]
    s_waitcnt lgkmcnt(0)
    v_mfma_f32_32x32x16_bf16 v[64:79], v[26:29], v[34:37], v[64:79]
    v_mfma_f32_32x32x16_bf16 v[80:95], v[30:33], v[34:37], v[80:95]
    v_mfma_f32_32x32x16_bf16 v[64:79], v[38:41], v[46:49], v[64:79]
    v_mfma_f32_32x32x16_bf16 v[80:95], v[42:45], v[46:49], v[80:95]
    s_lshr_b32 s30, s2, 3
    s_mul_i32 s30, s30, 65536
    s_add_u32 s30, s30, 8388608
    v_lshlrev_b32 v23, 7, v0
    v_add_u32 v23, s30, v23
    global_load_dword v59, v23, s[22:23] sc1
    s_setprio 0
    s_and_b32 s27, s3, 1
    s_lshl_b32 s27, s27, 8
    v_lshlrev_b32 v25, 4, v4
    v_add_u32 v25, s27, v25
    s_waitcnt vmcnt(1)
    s_barrier
    ds_read_b128 v[96:99], v25 offset:16384
    ds_read_b128 v[100:103], v25 offset:16416
    ds_read_b128 v[104:107], v25 offset:16448
    ds_read_b128 v[108:111], v25 offset:16480
    ds_read_b128 v[112:115], v25 offset:16512
    ds_read_b128 v[116:119], v25 offset:16544
    ds_read_b128 v[120:123], v25 offset:16576
    ds_read_b128 v[124:127], v25 offset:16608
    ds_read_b128 v[26:29], v25 offset:17408
    ds_read_b128 v[30:33], v25 offset:17440
    ds_read_b128 v[34:37], v25 offset:17472
    ds_read_b128 v[38:41], v25 offset:17504
    ds_read_b128 v[8:11], v25 offset:17536
    ds_read_b128 v[12:15], v25 offset:17568
    ds_read_b128 v[16:19], v25 offset:17600
    ds_read_b128 v[60:63], v25 offset:17632
    s_lshl_b32 s26, s24, 3
    s_lshr_b32 s27, s3, 1
    s_lshl_b32 s27, s27, 1
    s_add_u32 s26, s26, s27
    v_lshrrev_b32 v5, 4, v3
    v_add_u32 v5, s26, v5
    v_mul_u32_u24 v5, 57344, v5
    v_and_b32 v6, 15, v3
    v_lshlrev_b32 v6, 4, v6
    v_add_u32 v5, v5, v6
    v_lshlrev_b32 v6, 8, v4
    v_add_u32 v5, v5, v6
    s_lshl_b32 s26, s25, 2
    s_and_b32 s27, s3, 1
    s_lshl_b32 s27, s27, 1
    s_add_u32 s26, s26, s27
    s_lshl_b32 s26, s26, 10
    s_mov_b32 s27, 0x3fb8aa3b
    s_waitcnt lgkmcnt(0)
    v_fma_f32 v96, -v20, v96, v26
    v_fma_f32 v97, -v20, v97, v27
    v_fma_f32 v98, -v20, v98, v28
    v_fma_f32 v99, -v20, v99, v29
    v_fma_f32 v100, -v20, v100, v30
    v_fma_f32 v101, -v20, v101, v31
    v_fma_f32 v102, -v20, v102, v32
    v_fma_f32 v103, -v20, v103, v33
    v_fma_f32 v64, v64, v21, v96
    v_fma_f32 v65, v65, v21, v97
    v_fma_f32 v66, v66, v21, v98
    v_fma_f32 v67, v67, v21, v99
    v_fma_f32 v68, v68, v21, v100
    v_fma_f32 v69, v69, v21, v101
    v_fma_f32 v70, v70, v21, v102
    v_fma_f32 v71, v71, v21, v103
    v_cvt_pk_bf16_f32 v42, v64, v65
    v_cvt_pk_bf16_f32 v43, v66, v67
    v_cvt_pk_bf16_f32 v44, v68, v69
    v_cvt_pk_bf16_f32 v45, v70, v71
    v_lshlrev_b32 v64, 16, v42
    v_and_b32 v65, 0xffff0000, v42
    v_lshlrev_b32 v66, 16, v43
    v_and_b32 v67, 0xffff0000, v43
    v_lshlrev_b32 v68, 16, v44
    v_and_b32 v69, 0xffff0000, v44
    v_lshlrev_b32 v70, 16, v45
    v_and_b32 v71, 0xffff0000, v45
    v_mul_f32 v42, s27, v64
    v_mul_f32 v43, s27, v65
    v_mul_f32 v44, s27, v66
    v_mul_f32 v45, s27, v67
    v_mul_f32 v46, s27, v68
    v_mul_f32 v47, s27, v69
    v_mul_f32 v48, s27, v70
    v_mul_f32 v49, s27, v71
    v_exp_f32 v42, v42
    v_exp_f32 v43, v43
    v_exp_f32 v44, v44
    v_exp_f32 v45, v45
    v_exp_f32 v46, v46
    v_exp_f32 v47, v47
    v_exp_f32 v48, v48
    v_exp_f32 v49, v49
    v_add_f32 v50, 2.0, v42
    v_add_f32 v51, 2.0, v43
    v_add_f32 v52, 2.0, v44
    v_add_f32 v53, 2.0, v45
    v_add_f32 v54, 2.0, v46
    v_add_f32 v55, 2.0, v47
    v_add_f32 v56, 2.0, v48
    v_add_f32 v57, 2.0, v49
    v_fma_f32 v42, v42, v50, 2.0
    v_fma_f32 v43, v43, v51, 2.0
    v_fma_f32 v44, v44, v52, 2.0
    v_fma_f32 v45, v45, v53, 2.0
    v_fma_f32 v46, v46, v54, 2.0
    v_fma_f32 v47, v47, v55, 2.0
    v_fma_f32 v48, v48, v56, 2.0
    v_fma_f32 v49, v49, v57, 2.0
    v_rcp_f32 v42, v42
    v_rcp_f32 v43, v43
    v_rcp_f32 v44, v44
    v_rcp_f32 v45, v45
    v_rcp_f32 v46, v46
    v_rcp_f32 v47, v47
    v_rcp_f32 v48, v48
    v_rcp_f32 v49, v49
    v_fma_f32 v42, -2.0, v42, 1.0
    v_fma_f32 v43, -2.0, v43, 1.0
    v_fma_f32 v44, -2.0, v44, 1.0
    v_fma_f32 v45, -2.0, v45, 1.0
    v_fma_f32 v46, -2.0, v46, 1.0
    v_fma_f32 v47, -2.0, v47, 1.0
    v_fma_f32 v48, -2.0, v48, 1.0
    v_fma_f32 v49, -2.0, v49, 1.0
    v_mul_f32 v42, v42, v64
    v_mul_f32 v43, v43, v65
    v_mul_f32 v44, v44, v66
    v_mul_f32 v45, v45, v67
    v_mul_f32 v46, v46, v68
    v_mul_f32 v47, v47, v69
    v_mul_f32 v48, v48, v70
    v_mul_f32 v49, v49, v71
    v_cvt_pk_bf16_f32 v64, v42, v43
    v_cvt_pk_bf16_f32 v65, v44, v45
    v_cvt_pk_bf16_f32 v66, v46, v47
    v_cvt_pk_bf16_f32 v67, v48, v49
    s_nop 1
    v_permlane32_swap_b32 v64, v66
    v_permlane32_swap_b32 v65, v67
    s_nop 0
    buffer_store_dwordx4 v[64:67], v5, s[16:19], s26 offen offset:0 sc1
    v_fma_f32 v104, -v20, v104, v34
    v_fma_f32 v105, -v20, v105, v35
    v_fma_f32 v106, -v20, v106, v36
    v_fma_f32 v107, -v20, v107, v37
    v_fma_f32 v108, -v20, v108, v38
    v_fma_f32 v109, -v20, v109, v39
    v_fma_f32 v110, -v20, v110, v40
    v_fma_f32 v111, -v20, v111, v41
    v_fma_f32 v72, v72, v21, v104
    v_fma_f32 v73, v73, v21, v105
    v_fma_f32 v74, v74, v21, v106
    v_fma_f32 v75, v75, v21, v107
    v_fma_f32 v76, v76, v21, v108
    v_fma_f32 v77, v77, v21, v109
    v_fma_f32 v78, v78, v21, v110
    v_fma_f32 v79, v79, v21, v111
    v_cvt_pk_bf16_f32 v42, v72, v73
    v_cvt_pk_bf16_f32 v43, v74, v75
    v_cvt_pk_bf16_f32 v44, v76, v77
    v_cvt_pk_bf16_f32 v45, v78, v79
    v_lshlrev_b32 v72, 16, v42
    v_and_b32 v73, 0xffff0000, v42
    v_lshlrev_b32 v74, 16, v43
    v_and_b32 v75, 0xffff0000, v43
    v_lshlrev_b32 v76, 16, v44
    v_and_b32 v77, 0xffff0000, v44
    v_lshlrev_b32 v78, 16, v45
    v_and_b32 v79, 0xffff0000, v45
    v_mul_f32 v42, s27, v72
    v_mul_f32 v43, s27, v73
    v_mul_f32 v44, s27, v74
    v_mul_f32 v45, s27, v75
    v_mul_f32 v46, s27, v76
    v_mul_f32 v47, s27, v77
    v_mul_f32 v48, s27, v78
    v_mul_f32 v49, s27, v79
    v_exp_f32 v42, v42
    v_exp_f32 v43, v43
    v_exp_f32 v44, v44
    v_exp_f32 v45, v45
    v_exp_f32 v46, v46
    v_exp_f32 v47, v47
    v_exp_f32 v48, v48
    v_exp_f32 v49, v49
    v_add_f32 v50, 2.0, v42
    v_add_f32 v51, 2.0, v43
    v_add_f32 v52, 2.0, v44
    v_add_f32 v53, 2.0, v45
    v_add_f32 v54, 2.0, v46
    v_add_f32 v55, 2.0, v47
    v_add_f32 v56, 2.0, v48
    v_add_f32 v57, 2.0, v49
    v_fma_f32 v42, v42, v50, 2.0
    v_fma_f32 v43, v43, v51, 2.0
    v_fma_f32 v44, v44, v52, 2.0
    v_fma_f32 v45, v45, v53, 2.0
    v_fma_f32 v46, v46, v54, 2.0
    v_fma_f32 v47, v47, v55, 2.0
    v_fma_f32 v48, v48, v56, 2.0
    v_fma_f32 v49, v49, v57, 2.0
    v_rcp_f32 v42, v42
    v_rcp_f32 v43, v43
    v_rcp_f32 v44, v44
    v_rcp_f32 v45, v45
    v_rcp_f32 v46, v46
    v_rcp_f32 v47, v47
    v_rcp_f32 v48, v48
    v_rcp_f32 v49, v49
    v_fma_f32 v42, -2.0, v42, 1.0
    v_fma_f32 v43, -2.0, v43, 1.0
    v_fma_f32 v44, -2.0, v44, 1.0
    v_fma_f32 v45, -2.0, v45, 1.0
    v_fma_f32 v46, -2.0, v46, 1.0
    v_fma_f32 v47, -2.0, v47, 1.0
    v_fma_f32 v48, -2.0, v48, 1.0
    v_fma_f32 v49, -2.0, v49, 1.0
    v_mul_f32 v42, v42, v72
    v_mul_f32 v43, v43, v73
    v_mul_f32 v44, v44, v74
    v_mul_f32 v45, v45, v75
    v_mul_f32 v46, v46, v76
    v_mul_f32 v47, v47, v77
    v_mul_f32 v48, v48, v78
    v_mul_f32 v49, v49, v79
    v_cvt_pk_bf16_f32 v72, v42, v43
    v_cvt_pk_bf16_f32 v73, v44, v45
    v_cvt_pk_bf16_f32 v74, v46, v47
    v_cvt_pk_bf16_f32 v75, v48, v49
    s_nop 1
    v_permlane32_swap_b32 v72, v74
    v_permlane32_swap_b32 v73, v75
    s_nop 0
    buffer_store_dwordx4 v[72:75], v5, s[16:19], s26 offen offset:512 sc1
    v_fma_f32 v112, -v20, v112, v8
    v_fma_f32 v113, -v20, v113, v9
    v_fma_f32 v114, -v20, v114, v10
    v_fma_f32 v115, -v20, v115, v11
    v_fma_f32 v116, -v20, v116, v12
    v_fma_f32 v117, -v20, v117, v13
    v_fma_f32 v118, -v20, v118, v14
    v_fma_f32 v119, -v20, v119, v15
    v_fma_f32 v80, v80, v21, v112
    v_fma_f32 v81, v81, v21, v113
    v_fma_f32 v82, v82, v21, v114
    v_fma_f32 v83, v83, v21, v115
    v_fma_f32 v84, v84, v21, v116
    v_fma_f32 v85, v85, v21, v117
    v_fma_f32 v86, v86, v21, v118
    v_fma_f32 v87, v87, v21, v119
    v_cvt_pk_bf16_f32 v42, v80, v81
    v_cvt_pk_bf16_f32 v43, v82, v83
    v_cvt_pk_bf16_f32 v44, v84, v85
    v_cvt_pk_bf16_f32 v45, v86, v87
    v_lshlrev_b32 v80, 16, v42
    v_and_b32 v81, 0xffff0000, v42
    v_lshlrev_b32 v82, 16, v43
    v_and_b32 v83, 0xffff0000, v43
    v_lshlrev_b32 v84, 16, v44
    v_and_b32 v85, 0xffff0000, v44
    v_lshlrev_b32 v86, 16, v45
    v_and_b32 v87, 0xffff0000, v45
    v_mul_f32 v42, s27, v80
    v_mul_f32 v43, s27, v81
    v_mul_f32 v44, s27, v82
    v_mul_f32 v45, s27, v83
    v_mul_f32 v46, s27, v84
    v_mul_f32 v47, s27, v85
    v_mul_f32 v48, s27, v86
    v_mul_f32 v49, s27, v87
    v_exp_f32 v42, v42
    v_exp_f32 v43, v43
    v_exp_f32 v44, v44
    v_exp_f32 v45, v45
    v_exp_f32 v46, v46
    v_exp_f32 v47, v47
    v_exp_f32 v48, v48
    v_exp_f32 v49, v49
    v_add_f32 v50, 2.0, v42
    v_add_f32 v51, 2.0, v43
    v_add_f32 v52, 2.0, v44
    v_add_f32 v53, 2.0, v45
    v_add_f32 v54, 2.0, v46
    v_add_f32 v55, 2.0, v47
    v_add_f32 v56, 2.0, v48
    v_add_f32 v57, 2.0, v49
    v_fma_f32 v42, v42, v50, 2.0
    v_fma_f32 v43, v43, v51, 2.0
    v_fma_f32 v44, v44, v52, 2.0
    v_fma_f32 v45, v45, v53, 2.0
    v_fma_f32 v46, v46, v54, 2.0
    v_fma_f32 v47, v47, v55, 2.0
    v_fma_f32 v48, v48, v56, 2.0
    v_fma_f32 v49, v49, v57, 2.0
    v_rcp_f32 v42, v42
    v_rcp_f32 v43, v43
    v_rcp_f32 v44, v44
    v_rcp_f32 v45, v45
    v_rcp_f32 v46, v46
    v_rcp_f32 v47, v47
    v_rcp_f32 v48, v48
    v_rcp_f32 v49, v49
    v_fma_f32 v42, -2.0, v42, 1.0
    v_fma_f32 v43, -2.0, v43, 1.0
    v_fma_f32 v44, -2.0, v44, 1.0
    v_fma_f32 v45, -2.0, v45, 1.0
    v_fma_f32 v46, -2.0, v46, 1.0
    v_fma_f32 v47, -2.0, v47, 1.0
    v_fma_f32 v48, -2.0, v48, 1.0
    v_fma_f32 v49, -2.0, v49, 1.0
    v_mul_f32 v42, v42, v80
    v_mul_f32 v43, v43, v81
    v_mul_f32 v44, v44, v82
    v_mul_f32 v45, v45, v83
    v_mul_f32 v46, v46, v84
    v_mul_f32 v47, v47, v85
    v_mul_f32 v48, v48, v86
    v_mul_f32 v49, v49, v87
    v_cvt_pk_bf16_f32 v80, v42, v43
    v_cvt_pk_bf16_f32 v81, v44, v45
    v_cvt_pk_bf16_f32 v82, v46, v47
    v_cvt_pk_bf16_f32 v83, v48, v49
    s_nop 1
    v_permlane32_swap_b32 v80, v82
    v_permlane32_swap_b32 v81, v83
    s_nop 0
    buffer_store_dwordx4 v[80:83], v5, s[16:19], s26 offen offset:1024 sc1
    v_fma_f32 v120, -v20, v120, v16
    v_fma_f32 v121, -v20, v121, v17
    v_fma_f32 v122, -v20, v122, v18
    v_fma_f32 v123, -v20, v123, v19
    v_fma_f32 v124, -v20, v124, v60
    v_fma_f32 v125, -v20, v125, v61
    v_fma_f32 v126, -v20, v126, v62
    v_fma_f32 v127, -v20, v127, v63
    v_fma_f32 v88, v88, v21, v120
    v_fma_f32 v89, v89, v21, v121
    v_fma_f32 v90, v90, v21, v122
    v_fma_f32 v91, v91, v21, v123
    v_fma_f32 v92, v92, v21, v124
    v_fma_f32 v93, v93, v21, v125
    v_fma_f32 v94, v94, v21, v126
    v_fma_f32 v95, v95, v21, v127
    v_cvt_pk_bf16_f32 v42, v88, v89
    v_cvt_pk_bf16_f32 v43, v90, v91
    v_cvt_pk_bf16_f32 v44, v92, v93
    v_cvt_pk_bf16_f32 v45, v94, v95
    v_lshlrev_b32 v88, 16, v42
    v_and_b32 v89, 0xffff0000, v42
    v_lshlrev_b32 v90, 16, v43
    v_and_b32 v91, 0xffff0000, v43
    v_lshlrev_b32 v92, 16, v44
    v_and_b32 v93, 0xffff0000, v44
    v_lshlrev_b32 v94, 16, v45
    v_and_b32 v95, 0xffff0000, v45
    v_mul_f32 v42, s27, v88
    v_mul_f32 v43, s27, v89
    v_mul_f32 v44, s27, v90
    v_mul_f32 v45, s27, v91
    v_mul_f32 v46, s27, v92
    v_mul_f32 v47, s27, v93
    v_mul_f32 v48, s27, v94
    v_mul_f32 v49, s27, v95
    v_exp_f32 v42, v42
    v_exp_f32 v43, v43
    v_exp_f32 v44, v44
    v_exp_f32 v45, v45
    v_exp_f32 v46, v46
    v_exp_f32 v47, v47
    v_exp_f32 v48, v48
    v_exp_f32 v49, v49
    v_add_f32 v50, 2.0, v42
    v_add_f32 v51, 2.0, v43
    v_add_f32 v52, 2.0, v44
    v_add_f32 v53, 2.0, v45
    v_add_f32 v54, 2.0, v46
    v_add_f32 v55, 2.0, v47
    v_add_f32 v56, 2.0, v48
    v_add_f32 v57, 2.0, v49
    v_fma_f32 v42, v42, v50, 2.0
    v_fma_f32 v43, v43, v51, 2.0
    v_fma_f32 v44, v44, v52, 2.0
    v_fma_f32 v45, v45, v53, 2.0
    v_fma_f32 v46, v46, v54, 2.0
    v_fma_f32 v47, v47, v55, 2.0
    v_fma_f32 v48, v48, v56, 2.0
    v_fma_f32 v49, v49, v57, 2.0
    v_rcp_f32 v42, v42
    v_rcp_f32 v43, v43
    v_rcp_f32 v44, v44
    v_rcp_f32 v45, v45
    v_rcp_f32 v46, v46
    v_rcp_f32 v47, v47
    v_rcp_f32 v48, v48
    v_rcp_f32 v49, v49
    v_fma_f32 v42, -2.0, v42, 1.0
    v_fma_f32 v43, -2.0, v43, 1.0
    v_fma_f32 v44, -2.0, v44, 1.0
    v_fma_f32 v45, -2.0, v45, 1.0
    v_fma_f32 v46, -2.0, v46, 1.0
    v_fma_f32 v47, -2.0, v47, 1.0
    v_fma_f32 v48, -2.0, v48, 1.0
    v_fma_f32 v49, -2.0, v49, 1.0
    v_mul_f32 v42, v42, v88
    v_mul_f32 v43, v43, v89
    v_mul_f32 v44, v44, v90
    v_mul_f32 v45, v45, v91
    v_mul_f32 v46, v46, v92
    v_mul_f32 v47, v47, v93
    v_mul_f32 v48, v48, v94
    v_mul_f32 v49, v49, v95
    v_cvt_pk_bf16_f32 v88, v42, v43
    v_cvt_pk_bf16_f32 v89, v44, v45
    v_cvt_pk_bf16_f32 v90, v46, v47
    v_cvt_pk_bf16_f32 v91, v48, v49
    s_nop 1
    v_permlane32_swap_b32 v88, v90
    v_permlane32_swap_b32 v89, v91
    s_nop 0
    buffer_store_dwordx4 v[88:91], v5, s[16:19], s26 offen offset:1536 sc1
    s_lshl_b32 s60, s24, 1
    s_lshl_b32 s62, s25, 2
    s_mov_b32 s61, 1
    s_branch M_G2
M_G2PRE:
    s_waitcnt lgkmcnt(0)
    s_cmp_lg_u32 s3, 0
    s_cbranch_scc1 G2_NOPOLL0
    v_mov_b32 v15, 0
WZ_g2:
    global_load_dword v2, v15, s[20:21] sc1
    s_waitcnt vmcnt(0)
    v_cmp_eq_u32 vcc, 0, v2
    s_nop 3
    s_cmp_eq_u64 vcc, 0
    s_cbranch_scc1 WZD_g2
    s_sleep 8
    s_branch WZ_g2
WZD_g2:
    s_mov_b32 s62, 6557696
    v_min_u32 v15, 27, v1
    v_lshlrev_b32 v15, 2, v15
    v_add_u32 v15, s62, v15
    s_mov_b32 s63, 0x01010101
POLL_g2w0:
    global_load_dword v2, v15, s[22:23] sc1
    s_waitcnt vmcnt(0)
    v_cmp_ne_u32 vcc, s63, v2
    s_nop 3
    s_cmp_eq_u64 vcc, 0
    s_cbranch_scc1 POLLD_g2w0
    s_sleep 8
    s_branch POLL_g2w0
POLLD_g2w0:
    s_mov_b32 s62, 6561792
    v_min_u32 v15, 27, v1
    v_lshlrev_b32 v15, 2, v15
    v_add_u32 v15, s62, v15
    s_mov_b32 s63, 0x01010101
POLL_g2w1:
    global_load_dword v2, v15, s[22:23] sc1
    s_waitcnt vmcnt(0)
    v_cmp_ne_u32 vcc, s63, v2
    s_nop 3
    s_cmp_eq_u64 vcc, 0
    s_cbranch_scc1 POLLD_g2w1
    s_sleep 8
    s_branch POLL_g2w1
POLLD_g2w1:
    s_mov_b32 s62, 6565888
    v_min_u32 v15, 27, v1
    v_lshlrev_b32 v15, 2, v15
    v_add_u32 v15, s62, v15
    s_mov_b32 s63, 0x01010101
POLL_g2w2:
    global_load_dword v2, v15, s[22:23] sc1
    s_waitcnt vmcnt(0)
    v_cmp_ne_u32 vcc, s63, v2
    s_nop 3
    s_cmp_eq_u64 vcc, 0
    s_cbranch_scc1 POLLD_g2w2
    s_sleep 8
    s_branch POLL_g2w2
POLLD_g2w2:
    s_mov_b32 s62, 6569984
    v_min_u32 v15, 27, v1
    v_lshlrev_b32 v15, 2, v15
    v_add_u32 v15, s62, v15
    s_mov_b32 s63, 0x01010101
POLL_g2w3:
    global_load_dword v2, v15, s[22:23] sc1
    s_waitcnt vmcnt(0)
    v_cmp_ne_u32 vcc, s63, v2
    s_nop 3
    s_cmp_eq_u64 vcc, 0
    s_cbranch_scc1 POLLD_g2w3
    s_sleep 8
    s_branch POLL_g2w3
POLLD_g2w3:
G2_NOPOLL0:
    s_barrier
M_G2:
    s_and_b32 s25, s2, 7
    s_lshl_b32 s25, s25, 2
    s_lshr_b32 s24, s2, 3
    s_lshr_b32 s26, s24, 3
    s_add_u32 s25, s25, s26
    s_and_b32 s24, s24, 7
    s_mul_i32 s36, s3, 7168
    v_lshlrev_b32 v5, 4, v1
    v_add_u32 v8, s36, v5
    v_add_u32 v9, 4096, v8
    s_mul_i32 s40, s24, 229376
    s_add_u32 s41, s40, 57344
    s_add_u32 s42, s40, 114688
    s_add_u32 s43, s40, 172032
    s_mul_i32 s44, s25, 229376
    s_add_u32 s45, s44, 57344
    s_add_u32 s46, s44, 114688
    s_add_u32 s47, s44, 172032
    s_add_u32 s8, s22, 8388608
    s_addc_u32 s9, s23, 0
    s_mov_b32 s10, 1835008
    s_mov_b32 s11, 0x00020000
    s_add_u32 s12, s22, 12582912
    s_addc_u32 s13, s23, 0
    s_mov_b32 s14, 7340032
    s_mov_b32 s15, 0x00020000
    s_add_u32 s16, s22, 10485760
    s_addc_u32 s17, s23, 0
    s_mov_b32 s18, 2097152
    s_mov_b32 s19, 0x00020000
    s_mov_b32 s28, s56
    s_mov_b32 s29, s57
    s_mov_b32 s30, 2097152
    s_mov_b32 s31, 0x00020000
    s_mov_b32 s32, s58
    s_mov_b32 s33, s59
    s_mov_b32 s34, 2097152
    s_mov_b32 s35, 0x00020000
    buffer_load_dwordx4 v[80:83], v8, s[8:11], s40 offen offset:0 sc1
    buffer_load_dwordx4 v[84:87], v8, s[8:11], s41 offen offset:0 sc1
    buffer_load_dwordx4 v[88:91], v8, s[8:11], s42 offen offset:0 sc1
    buffer_load_dwordx4 v[92:95], v8, s[8:11], s43 offen offset:0 sc1
    buffer_load_dwordx4 v[96:99], v8, s[8:11], s40 offen offset:1024 sc1
    buffer_load_dwordx4 v[100:103], v8, s[8:11], s41 offen offset:1024 sc1
    buffer_load_dwordx4 v[104:107], v8, s[8:11], s42 offen offset:1024 sc1
    buffer_load_dwordx4 v[108:111], v8, s[8:11], s43 offen offset:1024 sc1
    v_and_b32 v3, 15, v1
    v_lshrrev_b32 v4, 4, v1
    s_lshl_b32 s37, s25, 6
    s_lshr_b32 s38, s3, 1
    s_lshl_b32 s38, s38, 4
    s_add_u32 s37, s37, s38
    v_add_u32 v6, s37, v3
    v_lshlrev_b32 v7, 10, v6
    v_lshlrev_b32 v14, 3, v4
    v_add_u32 v7, v7, v14
    s_lshl_b32 s38, s24, 7
    s_and_b32 s39, s3, 1
    s_lshl_b32 s48, s39, 6
    s_add_u32 s38, s38, s48
    v_add_u32 v7, s38, v7
    buffer_load_dwordx2 v[10:11], v7, s[28:31], 0 offen
    buffer_load_dwordx2 v[12:13], v7, s[28:31], 0 offen offset:32
    s_cmp_eq_u32 s61, 0
    s_cbranch_scc1 G2_NOSIG
    s_waitcnt vmcnt(10)
    s_barrier
    s_cmp_lg_u32 s3, 0
    s_cbranch_scc1 G2_NOSIG
    v_lshrrev_b32 v16, 3, v1
    v_add_u32 v16, s60, v16
    v_and_b32 v17, 7, v1
    v_and_b32 v18, 3, v16
    v_lshlrev_b32 v18, 3, v18
    v_add_u32 v18, v18, v17
    v_lshlrev_b32 v18, 3, v18
    v_lshrrev_b32 v19, 2, v16
    v_add_u32 v18, v18, v19
    v_lshlrev_b32 v18, 8, v18
    v_add_u32 v18, 6815744, v18
    v_add_u32 v18, s62, v18
    v_mov_b32 v19, 0x01010101
    v_cmp_gt_u32 vcc, 16, v1
    s_and_saveexec_b64 s[50:51], vcc
    global_store_dword v18, v19, s[22:23] sc1
    s_mov_b64 exec, s[50:51]
G2_NOSIG:
    v_mov_b32 v16, 0
    v_mov_b32 v17, 0
    v_mov_b32 v18, 0
    v_mov_b32 v19, 0
    v_mov_b32 v20, 0
    v_mov_b32 v21, 0
    v_mov_b32 v22, 0
    v_mov_b32 v23, 0
    v_mov_b32 v24, 0
    v_mov_b32 v25, 0
    v_mov_b32 v26, 0
    v_mov_b32 v27, 0
    v_mov_b32 v28, 0
    v_mov_b32 v29, 0
    v_mov_b32 v30, 0
    v_mov_b32 v31, 0
    v_mov_b32 v32, 0
    v_mov_b32 v33, 0
    v_mov_b32 v34, 0
    v_mov_b32 v35, 0
    v_mov_b32 v36, 0
    v_mov_b32 v37, 0
    v_mov_b32 v38, 0
    v_mov_b32 v39, 0
    v_mov_b32 v40, 0
    v_mov_b32 v41, 0
    v_mov_b32 v42, 0
    v_mov_b32 v43, 0
    v_mov_b32 v44, 0
    v_mov_b32 v45, 0
    v_mov_b32 v46, 0
    v_mov_b32 v47, 0
    v_mov_b32 v48, 0
    v_mov_b32 v49, 0
    v_mov_b32 v50, 0
    v_mov_b32 v51, 0
    v_mov_b32 v52, 0
    v_mov_b32 v53, 0
    v_mov_b32 v54, 0
    v_mov_b32 v55, 0
    v_mov_b32 v56, 0
    v_mov_b32 v57, 0
    v_mov_b32 v58, 0
    v_mov_b32 v59, 0
    v_mov_b32 v60, 0
    v_mov_b32 v61, 0
    v_mov_b32 v62, 0
    v_mov_b32 v63, 0
    v_mov_b32 v64, 0
    v_mov_b32 v65, 0
    v_mov_b32 v66, 0
    v_mov_b32 v67, 0
    v_mov_b32 v68, 0
    v_mov_b32 v69, 0
    v_mov_b32 v70, 0
    v_mov_b32 v71, 0
    v_mov_b32 v72, 0
    v_mov_b32 v73, 0
    v_mov_b32 v74, 0
    v_mov_b32 v75, 0
    v_mov_b32 v76, 0
    v_mov_b32 v77, 0
    v_mov_b32 v78, 0
    v_mov_b32 v79, 0
    s_mul_i32 s37, s3, 224
    s_lshr_b32 s38, s37, 7
    s_add_u32 s37, s37, 223
    s_lshr_b32 s37, s37, 7
    s_lshl_b32 s48, s2, 8
    s_add_u32 s48, s48, 6815744
    v_add_u32 v15, s38, v1
    v_min_u32 v15, s37, v15
    v_lshlrev_b32 v15, 2, v15
    v_add_u32 v15, s48, v15
    s_mov_b32 s49, 0x01010101
POLL_g2a:
    global_load_dword v2, v15, s[22:23] sc1
    s_waitcnt vmcnt(0)
    v_cmp_ne_u32 vcc, s49, v2
    s_nop 3
    s_cmp_eq_u64 vcc, 0
    s_cbranch_scc1 POLLD_g2a
    s_sleep 8
    s_branch POLL_g2a
POLLD_g2a:
    buffer_load_dwordx4 v[112:115], v8, s[12:15], s44 offen offset:0 sc1
    buffer_load_dwordx4 v[116:119], v8, s[12:15], s45 offen offset:0 sc1
    buffer_load_dwordx4 v[120:123], v8, s[12:15], s46 offen offset:0 sc1
    buffer_load_dwordx4 v[124:127], v8, s[12:15], s47 offen offset:0 sc1
    s_waitcnt vmcnt(3)
    v_mfma_f32_16x16x32_bf16 v[16:19], v[80:83], v[112:115], v[16:19]
    v_mfma_f32_16x16x32_bf16 v[32:35], v[84:87], v[112:115], v[32:35]
    v_mfma_f32_16x16x32_bf16 v[48:51], v[88:91], v[112:115], v[48:51]
    v_mfma_f32_16x16x32_bf16 v[64:67], v[92:95], v[112:115], v[64:67]
    buffer_load_dwordx4 v[112:115], v8, s[12:15], s44 offen offset:1024 sc1
    s_waitcnt vmcnt(3)
    v_mfma_f32_16x16x32_bf16 v[20:23], v[80:83], v[116:119], v[20:23]
    v_mfma_f32_16x16x32_bf16 v[36:39], v[84:87], v[116:119], v[36:39]
    v_mfma_f32_16x16x32_bf16 v[52:55], v[88:91], v[116:119], v[52:55]
    v_mfma_f32_16x16x32_bf16 v[68:71], v[92:95], v[116:119], v[68:71]
    buffer_load_dwordx4 v[116:119], v8, s[12:15], s45 offen offset:1024 sc1
    s_waitcnt vmcnt(3)
    v_mfma_f32_16x16x32_bf16 v[24:27], v[80:83], v[120:123], v[24:27]
    v_mfma_f32_16x16x32_bf16 v[40:43], v[84:87], v[120:123], v[40:43]
    v_mfma_f32_16x16x32_bf16 v[56:59], v[88:91], v[120:123], v[56:59]
    v_mfma_f32_16x16x32_bf16 v[72:75], v[92:95], v[120:123], v[72:75]
    buffer_load_dwordx4 v[120:123], v8, s[12:15], s46 offen offset:1024 sc1
    s_waitcnt vmcnt(3)
    v_mfma_f32_16x16x32_bf16 v[28:31], v[80:83], v[124:127], v[28:31]
    v_mfma_f32_16x16x32_bf16 v[44:47], v[84:87], v[124:127], v[44:47]
    v_mfma_f32_16x16x32_bf16 v[60:63], v[88:91], v[124:127], v[60:63]
    v_mfma_f32_16x16x32_bf16 v[76:79], v[92:95], v[124:127], v[76:79]
    buffer_load_dwordx4 v[124:127], v8, s[12:15], s47 offen offset:1024 sc1
    buffer_load_dwordx4 v[80:83], v8, s[8:11], s40 offen offset:2048 sc1
    buffer_load_dwordx4 v[84:87], v8, s[8:11], s41 offen offset:2048 sc1
    buffer_load_dwordx4 v[88:91], v8, s[8:11], s42 offen offset:2048 sc1
    buffer_load_dwordx4 v[92:95], v8, s[8:11], s43 offen offset:2048 sc1
    s_waitcnt vmcnt(7)
    v_mfma_f32_16x16x32_bf16 v[16:19], v[96:99], v[112:115], v[16:19]
    v_mfma_f32_16x16x32_bf16 v[32:35], v[100:103], v[112:115], v[32:35]
    v_mfma_f32_16x16x32_bf16 v[48:51], v[104:107], v[112:115], v[48:51]
    v_mfma_f32_16x16x32_bf16 v[64:67], v[108:111], v[112:115], v[64:67]
    buffer_load_dwordx4 v[112:115], v8, s[12:15], s44 offen offset:2048 sc1
    s_waitcnt vmcnt(7)
    v_mfma_f32_16x16x32_bf16 v[20:23], v[96:99], v[116:119], v[20:23]
    v_mfma_f32_16x16x32_bf16 v[36:39], v[100:103], v[116:119], v[36:39]
    v_mfma_f32_16x16x32_bf16 v[52:55], v[104:107], v[116:119], v[52:55]
    v_mfma_f32_16x16x32_bf16 v[68:71], v[108:111], v[116:119], v[68:71]
    buffer_load_dwordx4 v[116:119], v8, s[12:15], s45 offen offset:2048 sc1
    s_waitcnt vmcnt(7)
    v_mfma_f32_16x16x32_bf16 v[24:27], v[96:99], v[120:123], v[24:27]
    v_mfma_f32_16x16x32_bf16 v[40:43], v[100:103], v[120:123], v[40:43]
    v_mfma_f32_16x16x32_bf16 v[56:59], v[104:107], v[120:123], v[56:59]
    v_mfma_f32_16x16x32_bf16 v[72:75], v[108:111], v[120:123], v[72:75]
    buffer_load_dwordx4 v[120:123], v8, s[12:15], s46 offen offset:2048 sc1
    s_waitcnt vmcnt(7)
    v_mfma_f32_16x16x32_bf16 v[28:31], v[96:99], v[124:127], v[28:31]
    v_mfma_f32_16x16x32_bf16 v[44:47], v[100:103], v[124:127], v[44:47]
    v_mfma_f32_16x16x32_bf16 v[60:63], v[104:107], v[124:127], v[60:63]
    v_mfma_f32_16x16x32_bf16 v[76:79], v[108:111], v[124:127], v[76:79]
    buffer_load_dwordx4 v[124:127], v8, s[12:15], s47 offen offset:2048 sc1
    buffer_load_dwordx4 v[96:99], v8, s[8:11], s40 offen offset:3072 sc1
    buffer_load_dwordx4 v[100:103], v8, s[8:11], s41 offen offset:3072 sc1
    buffer_load_dwordx4 v[104:107], v8, s[8:11], s42 offen offset:3072 sc1
    buffer_load_dwordx4 v[108:111], v8, s[8:11], s43 offen offset:3072 sc1
    s_waitcnt vmcnt(7)
    v_mfma_f32_16x16x32_bf16 v[16:19], v[80:83], v[112:115], v[16:19]
    v_mfma_f32_16x16x32_bf16 v[32:35], v[84:87], v[112:115], v[32:35]
    v_mfma_f32_16x16x32_bf16 v[48:51], v[88:91], v[112:115], v[48:51]
    v_mfma_f32_16x16x32_bf16 v[64:67], v[92:95], v[112:115], v[64:67]
    buffer_load_dwordx4 v[112:115], v8, s[12:15], s44 offen offset:3072 sc1
    s_waitcnt vmcnt(7)
    v_mfma_f32_16x16x32_bf16 v[20:23], v[80:83], v[116:119], v[20:23]
    v_mfma_f32_16x16x32_bf16 v[36:39], v[84:87], v[116:119], v[36:39]
    v_mfma_f32_16x16x32_bf16 v[52:55], v[88:91], v[116:119], v[52:55]
    v_mfma_f32_16x16x32_bf16 v[68:71], v[92:95], v[116:119], v[68:71]
    buffer_load_dwordx4 v[116:119], v8, s[12:15], s45 offen offset:3072 sc1
    s_waitcnt vmcnt(7)
    v_mfma_f32_16x16x32_bf16 v[24:27], v[80:83], v[120:123], v[24:27]
    v_mfma_f32_16x16x32_bf16 v[40:43], v[84:87], v[120:123], v[40:43]
    v_mfma_f32_16x16x32_bf16 v[56:59], v[88:91], v[120:123], v[56:59]
    v_mfma_f32_16x16x32_bf16 v[72:75], v[92:95], v[120:123], v[72:75]
    buffer_load_dwordx4 v[120:123], v8, s[12:15], s46 offen offset:3072 sc1
    s_waitcnt vmcnt(7)
    v_mfma_f32_16x16x32_bf16 v[28:31], v[80:83], v[124:127], v[28:31]
    v_mfma_f32_16x16x32_bf16 v[44:47], v[84:87], v[124:127], v[44:47]
    v_mfma_f32_16x16x32_bf16 v[60:63], v[88:91], v[124:127], v[60:63]
    v_mfma_f32_16x16x32_bf16 v[76:79], v[92:95], v[124:127], v[76:79]
    buffer_load_dwordx4 v[124:127], v8, s[12:15], s47 offen offset:3072 sc1
    buffer_load_dwordx4 v[80:83], v9, s[8:11], s40 offen offset:0 sc1
    buffer_load_dwordx4 v[84:87], v9, s[8:11], s41 offen offset:0 sc1
    buffer_load_dwordx4 v[88:91], v9, s[8:11], s42 offen offset:0 sc1
    buffer_load_dwordx4 v[92:95], v9, s[8:11], s43 offen offset:0 sc1
    s_waitcnt vmcnt(7)
    v_mfma_f32_16x16x32_bf16 v[16:19], v[96:99], v[112:115], v[16:19]
    v_mfma_f32_16x16x32_bf16 v[32:35], v[100:103], v[112:115], v[32:35]
    v_mfma_f32_16x16x32_bf16 v[48:51], v[104:107], v[112:115], v[48:51]
    v_mfma_f32_16x16x32_bf16 v[64:67], v[108:111], v[112:115], v[64:67]
    buffer_load_dwordx4 v[112:115], v9, s[12:15], s44 offen offset:0 sc1
    s_waitcnt vmcnt(7)
    v_mfma_f32_16x16x32_bf16 v[20:23], v[96:99], v[116:119], v[20:23]
    v_mfma_f32_16x16x32_bf16 v[36:39], v[100:103], v[116:119], v[36:39]
    v_mfma_f32_16x16x32_bf16 v[52:55], v[104:107], v[116:119], v[52:55]
    v_mfma_f32_16x16x32_bf16 v[68:71], v[108:111], v[116:119], v[68:71]
    buffer_load_dwordx4 v[116:119], v9, s[12:15], s45 offen offset:0 sc1
    s_waitcnt vmcnt(7)
    v_mfma_f32_16x16x32_bf16 v[24:27], v[96:99], v[120:123], v[24:27]
    v_mfma_f32_16x16x32_bf16 v[40:43], v[100:103], v[120:123], v[40:43]
    v_mfma_f32_16x16x32_bf16 v[56:59], v[104:107], v[120:123], v[56:59]
    v_mfma_f32_16x16x32_bf16 v[72:75], v[108:111], v[120:123], v[72:75]
    buffer_load_dwordx4 v[120:123], v9, s[12:15], s46 offen offset:0 sc1
    s_waitcnt vmcnt(7)
    v_mfma_f32_16x16x32_bf16 v[28:31], v[96:99], v[124:127], v[28:31]
    v_mfma_f32_16x16x32_bf16 v[44:47], v[100:103], v[124:127], v[44:47]
    v_mfma_f32_16x16x32_bf16 v[60:63], v[104:107], v[124:127], v[60:63]
    v_mfma_f32_16x16x32_bf16 v[76:79], v[108:111], v[124:127], v[76:79]
    buffer_load_dwordx4 v[124:127], v9, s[12:15], s47 offen offset:0 sc1
    buffer_load_dwordx4 v[96:99], v9, s[8:11], s40 offen offset:1024 sc1
    buffer_load_dwordx4 v[100:103], v9, s[8:11], s41 offen offset:1024 sc1
    buffer_load_dwordx4 v[104:107], v9, s[8:11], s42 offen offset:1024 sc1
    buffer_load_dwordx4 v[108:111], v9, s[8:11], s43 offen offset:1024 sc1
    s_waitcnt vmcnt(7)
    v_mfma_f32_16x16x32_bf16 v[16:19], v[80:83], v[112:115], v[16:19]
    v_mfma_f32_16x16x32_bf16 v[32:35], v[84:87], v[112:115], v[32:35]
    v_mfma_f32_16x16x32_bf16 v[48:51], v[88:91], v[112:115], v[48:51]
    v_mfma_f32_16x16x32_bf16 v[64:67], v[92:95], v[112:115], v[64:67]
    buffer_load_dwordx4 v[112:115], v9, s[12:15], s44 offen offset:1024 sc1
    s_waitcnt vmcnt(7)
    v_mfma_f32_16x16x32_bf16 v[20:23], v[80:83], v[116:119], v[20:23]
    v_mfma_f32_16x16x32_bf16 v[36:39], v[84:87], v[116:119], v[36:39]
    v_mfma_f32_16x16x32_bf16 v[52:55], v[88:91], v[116:119], v[52:55]
    v_mfma_f32_16x16x32_bf16 v[68:71], v[92:95], v[116:119], v[68:71]
    buffer_load_dwordx4 v[116:119], v9, s[12:15], s45 offen offset:1024 sc1
    s_waitcnt vmcnt(7)
    v_mfma_f32_16x16x32_bf16 v[24:27], v[80:83], v[120:123], v[24:27]
    v_mfma_f32_16x16x32_bf16 v[40:43], v[84:87], v[120:123], v[40:43]
    v_mfma_f32_16x16x32_bf16 v[56:59], v[88:91], v[120:123], v[56:59]
    v_mfma_f32_16x16x32_bf16 v[72:75], v[92:95], v[120:123], v[72:75]
    buffer_load_dwordx4 v[120:123], v9, s[12:15], s46 offen offset:1024 sc1
    s_waitcnt vmcnt(7)
    v_mfma_f32_16x16x32_bf16 v[28:31], v[80:83], v[124:127], v[28:31]
    v_mfma_f32_16x16x32_bf16 v[44:47], v[84:87], v[124:127], v[44:47]
    v_mfma_f32_16x16x32_bf16 v[60:63], v[88:91], v[124:127], v[60:63]
    v_mfma_f32_16x16x32_bf16 v[76:79], v[92:95], v[124:127], v[76:79]
    buffer_load_dwordx4 v[124:127], v9, s[12:15], s47 offen offset:1024 sc1
    buffer_load_dwordx4 v[80:83], v9, s[8:11], s40 offen offset:2048 sc1
    buffer_load_dwordx4 v[84:87], v9, s[8:11], s41 offen offset:2048 sc1
    buffer_load_dwordx4 v[88:91], v9, s[8:11], s42 offen offset:2048 sc1
    buffer_load_dwordx4 v[92:95], v9, s[8:11], s43 offen offset:2048 sc1
    s_waitcnt vmcnt(7)
    v_mfma_f32_16x16x32_bf16 v[16:19], v[96:99], v[112:115], v[16:19]
    v_mfma_f32_16x16x32_bf16 v[32:35], v[100:103], v[112:115], v[32:35]
    v_mfma_f32_16x16x32_bf16 v[48:51], v[104:107], v[112:115], v[48:51]
    v_mfma_f32_16x16x32_bf16 v[64:67], v[108:111], v[112:115], v[64:67]
    buffer_load_dwordx4 v[112:115], v9, s[12:15], s44 offen offset:2048 sc1
    s_waitcnt vmcnt(7)
    v_mfma_f32_16x16x32_bf16 v[20:23], v[96:99], v[116:119], v[20:23]
    v_mfma_f32_16x16x32_bf16 v[36:39], v[100:103], v[116:119], v[36:39]
    v_mfma_f32_16x16x32_bf16 v[52:55], v[104:107], v[116:119], v[52:55]
    v_mfma_f32_16x16x32_bf16 v[68:71], v[108:111], v[116:119], v[68:71]
    buffer_load_dwordx4 v[116:119], v9, s[12:15], s45 offen offset:2048 sc1
    s_waitcnt vmcnt(7)
    v_mfma_f32_16x16x32_bf16 v[24:27], v[96:99], v[120:123], v[24:27]
    v_mfma_f32_16x16x32_bf16 v[40:43], v[100:103], v[120:123], v[40:43]
    v_mfma_f32_16x16x32_bf16 v[56:59], v[104:107], v[120:123], v[56:59]
    v_mfma_f32_16x16x32_bf16 v[72:75], v[108:111], v[120:123], v[72:75]
    buffer_load_dwordx4 v[120:123], v9, s[12:15], s46 offen offset:2048 sc1
    s_waitcnt vmcnt(7)
    v_mfma_f32_16x16x32_bf16 v[28:31], v[96:99], v[124:127], v[28:31]
    v_mfma_f32_16x16x32_bf16 v[44:47], v[100:103], v[124:127], v[44:47]
    v_mfma_f32_16x16x32_bf16 v[60:63], v[104:107], v[124:127], v[60:63]
    v_mfma_f32_16x16x32_bf16 v[76:79], v[108:111], v[124:127], v[76:79]
    buffer_load_dwordx4 v[124:127], v9, s[12:15], s47 offen offset:2048 sc1
    s_waitcnt vmcnt(3)
    v_mfma_f32_16x16x32_bf16 v[16:19], v[80:83], v[112:115], v[16:19]
    v_mfma_f32_16x16x32_bf16 v[32:35], v[84:87], v[112:115], v[32:35]
    v_mfma_f32_16x16x32_bf16 v[48:51], v[88:91], v[112:115], v[48:51]
    v_mfma_f32_16x16x32_bf16 v[64:67], v[92:95], v[112:115], v[64:67]
    s_waitcnt vmcnt(2)
    v_mfma_f32_16x16x32_bf16 v[20:23], v[80:83], v[116:119], v[20:23]
    v_mfma_f32_16x16x32_bf16 v[36:39], v[84:87], v[116:119], v[36:39]
    v_mfma_f32_16x16x32_bf16 v[52:55], v[88:91], v[116:119], v[52:55]
    v_mfma_f32_16x16x32_bf16 v[68:71], v[92:95], v[116:119], v[68:71]
    s_waitcnt vmcnt(1)
    v_mfma_f32_16x16x32_bf16 v[24:27], v[80:83], v[120:123], v[24:27]
    v_mfma_f32_16x16x32_bf16 v[40:43], v[84:87], v[120:123], v[40:43]
    v_mfma_f32_16x16x32_bf16 v[56:59], v[88:91], v[120:123], v[56:59]
    v_mfma_f32_16x16x32_bf16 v[72:75], v[92:95], v[120:123], v[72:75]
    s_waitcnt vmcnt(0)
    v_mfma_f32_16x16x32_bf16 v[28:31], v[80:83], v[124:127], v[28:31]
    v_mfma_f32_16x16x32_bf16 v[44:47], v[84:87], v[124:127], v[44:47]
    v_mfma_f32_16x16x32_bf16 v[60:63], v[88:91], v[124:127], v[60:63]
    v_mfma_f32_16x16x32_bf16 v[76:79], v[92:95], v[124:127], v[76:79]
    v_lshlrev_b32 v14, 14, v4
    v_lshlrev_b32 v6, 1, v6
    v_add_u32 v14, v14, v6
    s_and_b32 s39, s3, 1
    s_lshl_b32 s38, s24, 18
    s_lshl_b32 s48, s39, 17
    s_add_u32 s38, s38, s48
    v_add_u32 v14, s38, v14
    v_add_u32 v112, 4096, v14
    v_add_u32 v113, 8192, v14
    v_add_u32 v114, 12288, v14
    v_mov_b32 v115, v7
    s_and_b32 s36, s3, 3
    s_lshl_b32 s36, s36, 14
    v_add_u32 v6, s36, v5
    s_lshl_b32 s48, s2, 8
    s_add_u32 s48, s48, 6815808
    s_cmp_lt_u32 s3, 4
    s_cbranch_scc1 G2_LOW1
    ds_write_b128 v6, v[16:19] offset:0
    ds_write_b128 v6, v[20:23] offset:1024
    ds_write_b128 v6, v[24:27] offset:2048
    ds_write_b128 v6, v[28:31] offset:3072
    ds_write_b128 v6, v[32:35] offset:4096
    ds_write_b128 v6, v[36:39] offset:5120
    ds_write_b128 v6, v[40:43] offset:6144
    ds_write_b128 v6, v[44:47] offset:7168
    s_branch G2_J1
G2_LOW1:
    ds_write_b128 v6, v[48:51] offset:8192
    ds_write_b128 v6, v[52:55] offset:9216
    ds_write_b128 v6, v[56:59] offset:10240
    ds_write_b128 v6, v[60:63] offset:11264
    ds_write_b128 v6, v[64:67] offset:12288
    ds_write_b128 v6, v[68:71] offset:13312
    ds_write_b128 v6, v[72:75] offset:14336
    ds_write_b128 v6, v[76:79] offset:15360
    s_cmp_lg_u32 s3, 0
    s_cbranch_scc1 G2_J1
    v_min_u32 v15, 31, v1
    v_lshlrev_b32 v15, 2, v15
    v_add_u32 v15, s48, v15
    s_mov_b32 s49, 0x01010101
POLL_g2:
    global_load_dword v2, v15, s[22:23] sc1
    s_waitcnt vmcnt(0)
    v_cmp_ne_u32 vcc, s49, v2
    s_nop 3
    s_cmp_eq_u64 vcc, 0
    s_cbranch_scc1 POLLD_g2
    s_sleep 4
    s_branch POLL_g2
POLLD_g2:
G2_J1:
    s_waitcnt lgkmcnt(0)
    s_barrier
    s_mov_b32 s39, 65536
    buffer_load_ushort v116, v14, s[16:19], 0 offen sc1
    buffer_load_ushort v117, v112, s[16:19], 0 offen sc1
    buffer_load_ushort v118, v113, s[16:19], 0 offen sc1
    buffer_load_ushort v119, v114, s[16:19], 0 offen sc1
    buffer_load_ushort v120, v14, s[16:19], s39 offen sc1
    buffer_load_ushort v121, v112, s[16:19], s39 offen sc1
    buffer_load_ushort v122, v113, s[16:19], s39 offen sc1
    buffer_load_ushort v123, v114, s[16:19], s39 offen sc1
    s_cmp_ge_u32 s3, 4
    s_cbranch_scc1 G2_HI2
    ds_read_b128 v[80:83], v6 offset:0
    ds_read_b128 v[84:87], v6 offset:1024
    ds_read_b128 v[88:91], v6 offset:2048
    ds_read_b128 v[92:95], v6 offset:3072
    ds_read_b128 v[96:99], v6 offset:4096
    ds_read_b128 v[100:103], v6 offset:5120
    ds_read_b128 v[104:107], v6 offset:6144
    ds_read_b128 v[108:111], v6 offset:7168
    s_waitcnt lgkmcnt(7)
    v_add_f32 v16, v16, v80
    v_add_f32 v17, v17, v81
    v_add_f32 v18, v18, v82
    v_add_f32 v19, v19, v83
    s_waitcnt lgkmcnt(6)
    v_add_f32 v20, v20, v84
    v_add_f32 v21, v21, v85
    v_add_f32 v22, v22, v86
    v_add_f32 v23, v23, v87
    s_waitcnt lgkmcnt(5)
    v_add_f32 v24, v24, v88
    v_add_f32 v25, v25, v89
    v_add_f32 v26, v26, v90
    v_add_f32 v27, v27, v91
    s_waitcnt lgkmcnt(4)
    v_add_f32 v28, v28, v92
    v_add_f32 v29, v29, v93
    v_add_f32 v30, v30, v94
    v_add_f32 v31, v31, v95
    s_waitcnt lgkmcnt(3)
    v_add_f32 v32, v32, v96
    v_add_f32 v33, v33, v97
    v_add_f32 v34, v34, v98
    v_add_f32 v35, v35, v99
    s_waitcnt lgkmcnt(2)
    v_add_f32 v36, v36, v100
    v_add_f32 v37, v37, v101
    v_add_f32 v38, v38, v102
    v_add_f32 v39, v39, v103
    s_waitcnt lgkmcnt(1)
    v_add_f32 v40, v40, v104
    v_add_f32 v41, v41, v105
    v_add_f32 v42, v42, v106
    v_add_f32 v43, v43, v107
    s_waitcnt lgkmcnt(0)
    v_add_f32 v44, v44, v108
    v_add_f32 v45, v45, v109
    v_add_f32 v46, v46, v110
    v_add_f32 v47, v47, v111
    ds_write_b128 v6, v[16:19] offset:0
    ds_write_b128 v6, v[20:23] offset:1024
    ds_write_b128 v6, v[24:27] offset:2048
    ds_write_b128 v6, v[28:31] offset:3072
    ds_write_b128 v6, v[32:35] offset:4096
    ds_write_b128 v6, v[36:39] offset:5120
    ds_write_b128 v6, v[40:43] offset:6144
    ds_write_b128 v6, v[44:47] offset:7168
    s_branch G2_J2
G2_HI2:
    ds_read_b128 v[80:83], v6 offset:8192
    ds_read_b128 v[84:87], v6 offset:9216
    ds_read_b128 v[88:91], v6 offset:10240
    ds_read_b128 v[92:95], v6 offset:11264
    ds_read_b128 v[96:99], v6 offset:12288
    ds_read_b128 v[100:103], v6 offset:13312
    ds_read_b128 v[104:107], v6 offset:14336
    ds_read_b128 v[108:111], v6 offset:15360
    s_waitcnt lgkmcnt(7)
    v_add_f32 v48, v48, v80
    v_add_f32 v49, v49, v81
    v_add_f32 v50, v50, v82
    v_add_f32 v51, v51, v83
    s_waitcnt lgkmcnt(6)
    v_add_f32 v52, v52, v84
    v_add_f32 v53, v53, v85
    v_add_f32 v54, v54, v86
    v_add_f32 v55, v55, v87
    s_waitcnt lgkmcnt(5)
    v_add_f32 v56, v56, v88
    v_add_f32 v57, v57, v89
    v_add_f32 v58, v58, v90
    v_add_f32 v59, v59, v91
    s_waitcnt lgkmcnt(4)
    v_add_f32 v60, v60, v92
    v_add_f32 v61, v61, v93
    v_add_f32 v62, v62, v94
    v_add_f32 v63, v63, v95
    s_waitcnt lgkmcnt(3)
    v_add_f32 v64, v64, v96
    v_add_f32 v65, v65, v97
    v_add_f32 v66, v66, v98
    v_add_f32 v67, v67, v99
    s_waitcnt lgkmcnt(2)
    v_add_f32 v68, v68, v100
    v_add_f32 v69, v69, v101
    v_add_f32 v70, v70, v102
    v_add_f32 v71, v71, v103
    s_waitcnt lgkmcnt(1)
    v_add_f32 v72, v72, v104
    v_add_f32 v73, v73, v105
    v_add_f32 v74, v74, v106
    v_add_f32 v75, v75, v107
    s_waitcnt lgkmcnt(0)
    v_add_f32 v76, v76, v108
    v_add_f32 v77, v77, v109
    v_add_f32 v78, v78, v110
    v_add_f32 v79, v79, v111
    ds_write_b128 v6, v[48:51] offset:8192
    ds_write_b128 v6, v[52:55] offset:9216
    ds_write_b128 v6, v[56:59] offset:10240
    ds_write_b128 v6, v[60:63] offset:11264
    ds_write_b128 v6, v[64:67] offset:12288
    ds_write_b128 v6, v[68:71] offset:13312
    ds_write_b128 v6, v[72:75] offset:14336
    ds_write_b128 v6, v[76:79] offset:15360
G2_J2:
    s_and_b32 s37, s3, 1
    s_lshl_b32 s37, s37, 13
    s_lshr_b32 s38, s3, 1
    s_lshl_b32 s38, s38, 10
    s_add_u32 s37, s37, s38
    v_add_u32 v7, s37, v5
    s_waitcnt lgkmcnt(0)
    s_barrier
    ds_read_b128 v[16:19], v7 offset:0
    ds_read_b128 v[20:23], v7 offset:16384
    ds_read_b128 v[24:27], v7 offset:32768
    ds_read_b128 v[28:31], v7 offset:49152
    ds_read_b128 v[32:35], v7 offset:4096
    ds_read_b128 v[36:39], v7 offset:20480
    ds_read_b128 v[40:43], v7 offset:36864
    ds_read_b128 v[44:47], v7 offset:53248
    s_waitcnt lgkmcnt(0)
    v_add_f32 v16, v16, v20
    v_add_f32 v24, v24, v28
    v_add_f32 v17, v17, v21
    v_add_f32 v25, v25, v29
    v_add_f32 v18, v18, v22
    v_add_f32 v26, v26, v30
    v_add_f32 v19, v19, v23
    v_add_f32 v27, v27, v31
    v_add_f32 v16, v16, v24
    v_add_f32 v17, v17, v25
    v_add_f32 v18, v18, v26
    v_add_f32 v19, v19, v27
    v_add_f32 v32, v32, v36
    v_add_f32 v40, v40, v44
    v_add_f32 v33, v33, v37
    v_add_f32 v41, v41, v45
    v_add_f32 v34, v34, v38
    v_add_f32 v42, v42, v46
    v_add_f32 v35, v35, v39
    v_add_f32 v43, v43, v47
    v_add_f32 v32, v32, v40
    v_add_f32 v33, v33, v41
    v_add_f32 v34, v34, v42
    v_add_f32 v35, v35, v43
    s_waitcnt vmcnt(0)
    v_cvt_pk_bf16_f32 v20, v16, v17
    v_cvt_pk_bf16_f32 v21, v18, v19
    v_lshlrev_b32 v16, 16, v20
    v_and_b32 v17, 0xffff0000, v20
    v_lshlrev_b32 v18, 16, v21
    v_and_b32 v19, 0xffff0000, v21
    v_lshlrev_b32 v20, 16, v10
    v_and_b32 v21, 0xffff0000, v10
    v_lshlrev_b32 v22, 16, v11
    v_and_b32 v23, 0xffff0000, v11
    v_lshlrev_b32 v24, 16, v116
    v_lshlrev_b32 v25, 16, v117
    v_lshlrev_b32 v26, 16, v118
    v_lshlrev_b32 v27, 16, v119
    v_add_f32 v20, v20, v24
    v_add_f32 v21, v21, v25
    v_add_f32 v22, v22, v26
    v_add_f32 v23, v23, v27
    v_cvt_pk_bf16_f32 v24, v20, v21
    v_cvt_pk_bf16_f32 v25, v22, v23
    v_lshlrev_b32 v20, 16, v24
    v_and_b32 v21, 0xffff0000, v24
    v_lshlrev_b32 v22, 16, v25
    v_and_b32 v23, 0xffff0000, v25
    v_add_f32 v20, v20, v16
    v_add_f32 v21, v21, v17
    v_add_f32 v22, v22, v18
    v_add_f32 v23, v23, v19
    v_cvt_pk_bf16_f32 v24, v20, v21
    v_cvt_pk_bf16_f32 v25, v22, v23
    buffer_store_dwordx2 v[24:25], v115, s[32:35], 0 offen offset:0
    v_cvt_pk_bf16_f32 v36, v32, v33
    v_cvt_pk_bf16_f32 v37, v34, v35
    v_lshlrev_b32 v32, 16, v36
    v_and_b32 v33, 0xffff0000, v36
    v_lshlrev_b32 v34, 16, v37
    v_and_b32 v35, 0xffff0000, v37
    v_lshlrev_b32 v36, 16, v12
    v_and_b32 v37, 0xffff0000, v12
    v_lshlrev_b32 v38, 16, v13
    v_and_b32 v39, 0xffff0000, v13
    v_lshlrev_b32 v40, 16, v120
    v_lshlrev_b32 v41, 16, v121
    v_lshlrev_b32 v42, 16, v122
    v_lshlrev_b32 v43, 16, v123
    v_add_f32 v36, v36, v40
    v_add_f32 v37, v37, v41
    v_add_f32 v38, v38, v42
    v_add_f32 v39, v39, v43
    v_cvt_pk_bf16_f32 v40, v36, v37
    v_cvt_pk_bf16_f32 v41, v38, v39
    v_lshlrev_b32 v36, 16, v40
    v_and_b32 v37, 0xffff0000, v40
    v_lshlrev_b32 v38, 16, v41
    v_and_b32 v39, 0xffff0000, v41
    v_add_f32 v36, v36, v32
    v_add_f32 v37, v37, v33
    v_add_f32 v38, v38, v34
    v_add_f32 v39, v39, v35
    v_cvt_pk_bf16_f32 v40, v36, v37
    v_cvt_pk_bf16_f32 v41, v38, v39
    buffer_store_dwordx2 v[40:41], v115, s[32:35], 0 offen offset:32
    s_endpgm
M_END:
    s_endpgm
.section .rodata,"a"
.p2align 6
.amdhsa_kernel parallel_sum__ssm_conv_s4__dense_activation_mish__prompt_kernel
  .amdhsa_next_free_vgpr 128
  .amdhsa_next_free_sgpr 96
  .amdhsa_accum_offset 128
  .amdhsa_group_segment_fixed_size 0
  .amdhsa_kernarg_size 128
  .amdhsa_user_sgpr_count 2
  .amdhsa_user_sgpr_kernarg_segment_ptr 1
  .amdhsa_system_sgpr_workgroup_id_x 1
.end_amdhsa_kernel
```
